```python
import torch

def _softmax(x, axis=-1):
    return torch.softmax(x, dim=axis)
def _gelu(x):
    return torch.nn.functional.gelu(x, approximate="tanh")
def _silu(x):
    return torch.nn.functional.silu(x)
def _sigmoid(x):
    return torch.sigmoid(x)
def _layernorm(x, axis=-1, eps=1e-5):
    m = x.mean(dim=axis, keepdim=True)
    v = x.var(dim=axis, keepdim=True, unbiased=False)
    return (x - m) / torch.sqrt(v + eps)
def _scatter_add(tgt, idx, src, axis=0):
    return tgt.clone().index_add_(axis, idx, src)
def _segment_sum(src, seg, n):
    out = torch.zeros((n,) + src.shape[1:], dtype=src.dtype)
    return out.index_add_(0, seg, src)
def _pad(x, pw):
    flat = tuple(v for pair in reversed(pw) for v in pair)
    return torch.nn.functional.pad(x, flat)

kernel_name = 'parallel_sum__sliding_block_cached__glu_gated_bilinear__decode'

def setup_inputs():

    _w = (lambda a: (lambda t: t.to(torch.bfloat16) if t.is_floating_point() else t)(torch.as_tensor(a)))
    def _A_setup():
        B, Sq, D = 4, 1, 1024
        Hq, Hkv, Sk, Dh = 32, 4, 8192, 128
        assert Hq % Hkv == 0, (Hq, Hkv)
        return {
            "x": _w((lambda *s: torch.randn(*s, dtype=torch.bfloat16) * 0.05)(B, Sq, D)),
            "k_cache": _w((lambda *s: torch.randn(*s, dtype=torch.bfloat16) * 1.6)(B, Hkv, Sk, Dh)),
            "v_cache": _w((lambda *s: torch.randn(*s, dtype=torch.bfloat16) * 0.8)(B, Hkv, Sk, Dh)),
            "wq": _w((lambda *s: torch.randn(*s, dtype=torch.bfloat16) * 1.6)(D, Hq * Dh) * (D ** -0.5)),
            "wo": _w((lambda *s: torch.randn(*s, dtype=torch.bfloat16) * 0.8)(Hq * Dh, D) * ((Hq * Dh) ** -0.5)),
        }
    _A_in = _A_setup()

    def _B_setup():
        B, S, D, F = 4, 1, 1024, 3584
        return {
            "x": _w((lambda *s: torch.randn(*s, dtype=torch.bfloat16) * 0.05)(B, S, D)),
            "w_gate": _w((lambda *s: torch.randn(*s, dtype=torch.bfloat16) * 0.4)(D, F) * (D ** -0.5)),
            "w_up": _w((lambda *s: torch.randn(*s, dtype=torch.bfloat16) * 0.4)(D, F) * (D ** -0.5)),
            "w_down": _w((lambda *s: torch.randn(*s, dtype=torch.bfloat16) * 0.4)(F, D) * (F ** -0.5)),
        }
    _B_in = _B_setup()

    return {
        "A_x": _A_in["x"],
        "A_k_cache": _A_in["k_cache"],
        "A_v_cache": _A_in["v_cache"],
        "A_wq": _A_in["wq"],
        "A_wo": _A_in["wo"],
        "B_x": _B_in["x"],
        "B_w_gate": _B_in["w_gate"],
        "B_w_up": _B_in["w_up"],
        "B_w_down": _B_in["w_down"],
    }

def reference(A_x, A_k_cache, A_v_cache, A_wq, A_wo, B_x, B_w_gate, B_w_up, B_w_down):
    def _A_ref(x, k_cache, v_cache, wq, wo):
        B, Sq, D = x.shape
        Hq, Dh = 32, 128
        Hkv, Sk = k_cache.shape[1], k_cache.shape[2]
        W = min(4096, max(256, Sk // 4))
        rep = Hq // Hkv
        q = (lambda x, *d: x.permute(*d))((x @ wq).reshape(B, Sq, Hq, Dh), 0, 2, 1, 3)
        k = (lambda x, n, axis: torch.repeat_interleave(x, n, dim=axis))(k_cache[:, :, Sk - W:, :], rep, axis=1)
        v = (lambda x, n, axis: torch.repeat_interleave(x, n, dim=axis))(v_cache[:, :, Sk - W:, :], rep, axis=1)
        scores = torch.einsum("bhqd,bhkd->bhqk", q, k) * (Dh ** -0.5)
        p = _softmax(scores, axis=-1)
        o = torch.einsum("bhqk,bhkd->bhqd", p, v)
        return (lambda x, *d: x.permute(*d))(o, 0, 2, 1, 3).reshape(B, Sq, Hq * Dh) @ wo

    def _B_ref(x, w_gate, w_up, w_down):
        g = torch.einsum("bsd,df->bsf", x, w_gate)
        u = torch.einsum("bsd,df->bsf", x, w_up)
        h = g * u
        return torch.einsum("bsf,fd->bsd", h, w_down)

    x = A_x
    xn = _layernorm(x, axis=-1)
    return x + _A_ref(xn, A_k_cache, A_v_cache, A_wq, A_wo) + _B_ref(xn, B_w_gate, B_w_up, B_w_down)
```

```asm
; @launch grid=(256,1,1) block=(1024,1,1) lds=102400
.amdgcn_target "amdgcn-amd-amdhsa--gfx950"
.text
.globl parallel_sum__sliding_block_cached__glu_gated_bilinear__decode_kernel
.p2align 8
.type parallel_sum__sliding_block_cached__glu_gated_bilinear__decode_kernel,@function
parallel_sum__sliding_block_cached__glu_gated_bilinear__decode_kernel:
    s_cmp_ge_u32 s2, 256
    s_cbranch_scc1 L_exit
    s_load_dwordx16 s[16:31], s[0:1], 0
    s_load_dwordx8 s[32:39], s[0:1], 64
    s_getpc_b64 s[52:53]
L_pc_anchor:
    s_and_b32 s53, s53, 0xffff
    s_mov_b32 s54, L_code_end-L_pc_anchor
    s_mov_b32 s55, 0x20000
    v_lshlrev_b32 v1, 4, v0
    buffer_load_dwordx4 v[124:127], v1, s[52:55], 0 offen
L_nopf:
    v_lshrrev_b32 v1, 6, v0
    v_and_b32 v0, 63, v0
    v_readfirstlane_b32 s3, v1
    v_and_b32 v1, 15, v0
    v_lshrrev_b32 v2, 4, v0
    s_and_b32 s4, s2, 7
    s_lshr_b32 s5, s2, 3
    s_mov_b32 s7, 0x05040100
    s_mov_b32 s8, 0x07060302
    s_lshr_b32 s9, s3, 2
    s_and_b32 s10, s3, 3
    s_lshr_b32 s61, s2, 4
    s_and_b32 s62, s2, 15
    s_mov_b32 s64, 0x55555555
    s_mov_b32 s65, 0x55555555
    s_mov_b32 s66, 0x33333333
    s_mov_b32 s67, 0x33333333
    s_mov_b32 s88, 0xff0000ff
    s_mov_b32 s89, 0
    s_movk_i32 s91, 0xfff
    v_mov_b32 v6, 0
    v_mov_b32 v7, 1
    s_cmp_eq_u32 s9, 1
    s_cbranch_scc1 L_role1
    s_cmp_eq_u32 s9, 2
    s_cbranch_scc1 L_role2
    s_cmp_eq_u32 s9, 3
    s_cbranch_scc1 L_role3
    v_lshrrev_b32 v3, 3, v1
    v_lshlrev_b32 v3, 2, v3
    v_add_u32 v3, v3, v2
    v_mul_u32_u24 v3, 65536, v3
    v_and_b32 v4, 7, v1
    v_lshl_add_u32 v4, v4, 4, v3
    v_lshlrev_b32 v5, 4, v0
    s_lshr_b32 s12, s5, 2
    s_and_b32 s14, s5, 3
    s_lshl1_add_u32 s14, s14, s12
    s_lshr_b32 s13, s4, 2
    s_add_u32 s14, s14, s13
    s_and_b32 s14, s14, 7
    s_and_b32 s68, s4, 3
    s_lshr_b32 s13, s10, 1
    s_lshl2_add_u32 s13, s13, 3
    s_lshr_b32 s15, s12, 2
    s_and_b32 s11, s10, 1
    s_lshl1_add_u32 s11, s15, s11
    s_and_b32 s69, s12, 3
    s_cmp_eq_u32 s69, 3
    s_cselect_b32 s13, s13, s12
    s_cselect_b32 s11, s11, s10
    s_cselect_b32 s69, 1, 0
    s_lshl1_add_u32 s69, s15, s69
    s_lshl3_add_u32 s63, s14, s13
    s_lshl2_add_u32 s11, s68, s11
    s_lshl_b32 s56, s11, 19
    s_lshl_b32 s12, s63, 7
    s_add_u32 s56, s56, s12
    s_lshl_b32 s57, s10, 11
    s_waitcnt lgkmcnt(0)
    s_load_dword s90, s[38:39], 0
    s_mov_b32 s52, s16
    s_and_b32 s53, s17, 0xffff
    s_mov_b32 s54, 0x2000
    s_mov_b32 s55, 0x20000
    buffer_load_dwordx4 v[8:11], v5, s[52:55], s57 offen
    buffer_load_dwordx4 v[12:15], v5, s[52:55], s57 offen offset:1024
    s_mov_b32 s40, s22
    s_and_b32 s41, s23, 0xffff
    s_mov_b32 s42, 0x800000
    s_mov_b32 s43, 0x20000
    buffer_load_dwordx4 v[32:35], v4, s[40:43], s56 offen nt
    s_add_u32 s56, s56, 8192
    buffer_load_dwordx4 v[36:39], v4, s[40:43], s56 offen nt
    s_add_u32 s56, s56, 8192
    buffer_load_dwordx4 v[40:43], v4, s[40:43], s56 offen nt
    s_add_u32 s56, s56, 8192
    buffer_load_dwordx4 v[44:47], v4, s[40:43], s56 offen nt
    s_add_u32 s56, s56, 8192
    buffer_load_dwordx4 v[48:51], v4, s[40:43], s56 offen nt
    s_add_u32 s56, s56, 8192
    buffer_load_dwordx4 v[52:55], v4, s[40:43], s56 offen nt
    s_add_u32 s56, s56, 8192
    buffer_load_dwordx4 v[56:59], v4, s[40:43], s56 offen nt
    s_add_u32 s56, s56, 8192
    buffer_load_dwordx4 v[60:63], v4, s[40:43], s56 offen nt
    s_mov_b32 s48, s38
    s_and_b32 s49, s39, 0xffff
    s_mov_b32 s50, 0x400000
    s_mov_b32 s51, 0x20000
    v_lshlrev_b32 v3, 2, v0
    s_cmp_lg_u32 s10, 0
    s_cbranch_scc1 L_r0_noinit
    ds_write_b32 v3, v6 offset:0
L_r0_noinit:
    v_and_b32 v3, 3, v1
    v_lshlrev_b32 v3, 11, v3
    v_bfe_u32 v4, v1, 2, 1
    v_lshl_add_u32 v3, v4, 6, v3
    v_lshl_add_u32 v3, v2, 4, v3
    s_lshl_b32 s11, s11, 7
    v_add_u32 v3, s11, v3
    v_add_u32 v5, s57, v5
    s_waitcnt vmcnt(8)
    v_lshlrev_b32 v16, 16, v8
    v_and_b32 v17, 0xffff0000, v8
    v_lshlrev_b32 v18, 16, v9
    v_and_b32 v19, 0xffff0000, v9
    v_lshlrev_b32 v20, 16, v10
    v_and_b32 v21, 0xffff0000, v10
    v_lshlrev_b32 v22, 16, v11
    v_and_b32 v23, 0xffff0000, v11
    v_lshlrev_b32 v24, 16, v12
    v_and_b32 v25, 0xffff0000, v12
    v_lshlrev_b32 v26, 16, v13
    v_and_b32 v27, 0xffff0000, v13
    v_lshlrev_b32 v28, 16, v14
    v_and_b32 v29, 0xffff0000, v14
    v_lshlrev_b32 v30, 16, v15
    v_and_b32 v31, 0xffff0000, v15
    v_pk_add_f32 v[8:9], v[16:17], v[18:19]
    v_pk_add_f32 v[10:11], v[20:21], v[22:23]
    v_pk_add_f32 v[12:13], v[24:25], v[26:27]
    v_pk_add_f32 v[14:15], v[28:29], v[30:31]
    v_pk_add_f32 v[8:9], v[8:9], v[10:11]
    v_pk_add_f32 v[12:13], v[12:13], v[14:15]
    v_pk_add_f32 v[8:9], v[8:9], v[12:13]
    v_add_f32 v8, v8, v9
    s_nop 1
    v_add_f32_dpp v8, v8, v8 row_ror:8 row_mask:0xf bank_mask:0xf
    s_nop 1
    v_add_f32_dpp v8, v8, v8 row_ror:4 row_mask:0xf bank_mask:0xf
    s_nop 1
    v_add_f32_dpp v8, v8, v8 row_ror:2 row_mask:0xf bank_mask:0xf
    s_nop 1
    v_add_f32_dpp v8, v8, v8 row_ror:1 row_mask:0xf bank_mask:0xf
    v_mov_b32 v9, v8
    s_nop 1
    v_permlane16_swap_b32 v8, v9
    v_add_f32 v8, v8, v9
    v_mov_b32 v9, v8
    s_nop 1
    v_permlane32_swap_b32 v8, v9
    v_add_f32 v8, v8, v9
    v_mul_f32 v8, 0x3a800000, v8
    v_sub_f32 v10, v16, v8
    v_sub_f32 v11, v17, v8
    v_sub_f32 v12, v18, v8
    v_sub_f32 v13, v19, v8
    v_mul_f32 v116, v10, v10
    v_mul_f32 v117, v11, v11
    v_mul_f32 v118, v12, v12
    v_mul_f32 v119, v13, v13
    v_sub_f32 v10, v20, v8
    v_sub_f32 v11, v21, v8
    v_sub_f32 v12, v22, v8
    v_sub_f32 v13, v23, v8
    v_fmac_f32 v116, v10, v10
    v_fmac_f32 v117, v11, v11
    v_fmac_f32 v118, v12, v12
    v_fmac_f32 v119, v13, v13
    v_sub_f32 v10, v24, v8
    v_sub_f32 v11, v25, v8
    v_sub_f32 v12, v26, v8
    v_sub_f32 v13, v27, v8
    v_fmac_f32 v116, v10, v10
    v_fmac_f32 v117, v11, v11
    v_fmac_f32 v118, v12, v12
    v_fmac_f32 v119, v13, v13
    v_sub_f32 v10, v28, v8
    v_sub_f32 v11, v29, v8
    v_sub_f32 v12, v30, v8
    v_sub_f32 v13, v31, v8
    v_fmac_f32 v116, v10, v10
    v_fmac_f32 v117, v11, v11
    v_fmac_f32 v118, v12, v12
    v_fmac_f32 v119, v13, v13
    v_pk_add_f32 v[116:117], v[116:117], v[118:119]
    v_add_f32 v9, v116, v117
    s_nop 1
    v_add_f32_dpp v9, v9, v9 row_ror:8 row_mask:0xf bank_mask:0xf
    s_nop 1
    v_add_f32_dpp v9, v9, v9 row_ror:4 row_mask:0xf bank_mask:0xf
    s_nop 1
    v_add_f32_dpp v9, v9, v9 row_ror:2 row_mask:0xf bank_mask:0xf
    s_nop 1
    v_add_f32_dpp v9, v9, v9 row_ror:1 row_mask:0xf bank_mask:0xf
    v_mov_b32 v10, v9
    s_nop 1
    v_permlane16_swap_b32 v9, v10
    v_add_f32 v9, v9, v10
    v_mov_b32 v10, v9
    s_nop 1
    v_permlane32_swap_b32 v9, v10
    v_add_f32 v9, v9, v10
    v_mul_f32 v9, 0x3a800000, v9
    v_cvt_pk_bf16_f32 v8, v8, v8
    v_and_b32 v8, 0xffff0000, v8
    v_cvt_pk_bf16_f32 v9, v9, v9
    v_and_b32 v9, 0xffff0000, v9
    v_add_f32 v9, 0x3727c5ac, v9
    v_cvt_pk_bf16_f32 v9, v9, v9
    v_and_b32 v9, 0xffff0000, v9
    v_sqrt_f32 v9, v9
    v_sub_f32 v16, v16, v8
    v_sub_f32 v17, v17, v8
    v_sub_f32 v18, v18, v8
    v_sub_f32 v19, v19, v8
    v_sub_f32 v20, v20, v8
    v_sub_f32 v21, v21, v8
    v_sub_f32 v22, v22, v8
    v_sub_f32 v23, v23, v8
    v_sub_f32 v24, v24, v8
    v_sub_f32 v25, v25, v8
    v_sub_f32 v26, v26, v8
    v_sub_f32 v27, v27, v8
    v_sub_f32 v28, v28, v8
    v_sub_f32 v29, v29, v8
    v_sub_f32 v30, v30, v8
    v_sub_f32 v31, v31, v8
    v_cvt_pk_bf16_f32 v9, v9, v9
    v_and_b32 v9, 0xffff0000, v9
    v_rcp_f32 v9, v9
    v_cvt_pk_bf16_f32 v17, v16, v17
    v_cvt_pk_bf16_f32 v19, v18, v19
    v_cvt_pk_bf16_f32 v21, v20, v21
    v_cvt_pk_bf16_f32 v23, v22, v23
    v_cvt_pk_bf16_f32 v25, v24, v25
    v_cvt_pk_bf16_f32 v27, v26, v27
    v_cvt_pk_bf16_f32 v29, v28, v29
    v_cvt_pk_bf16_f32 v31, v30, v31
    v_lshlrev_b32 v16, 16, v17
    v_and_b32 v17, 0xffff0000, v17
    v_lshlrev_b32 v18, 16, v19
    v_and_b32 v19, 0xffff0000, v19
    v_lshlrev_b32 v20, 16, v21
    v_and_b32 v21, 0xffff0000, v21
    v_lshlrev_b32 v22, 16, v23
    v_and_b32 v23, 0xffff0000, v23
    v_lshlrev_b32 v24, 16, v25
    v_and_b32 v25, 0xffff0000, v25
    v_lshlrev_b32 v26, 16, v27
    v_and_b32 v27, 0xffff0000, v27
    v_lshlrev_b32 v28, 16, v29
    v_and_b32 v29, 0xffff0000, v29
    v_lshlrev_b32 v30, 16, v31
    v_and_b32 v31, 0xffff0000, v31
    v_mul_f32 v16, v16, v9
    v_mul_f32 v17, v17, v9
    v_mul_f32 v18, v18, v9
    v_mul_f32 v19, v19, v9
    v_mul_f32 v20, v20, v9
    v_mul_f32 v21, v21, v9
    v_mul_f32 v22, v22, v9
    v_mul_f32 v23, v23, v9
    v_mul_f32 v24, v24, v9
    v_mul_f32 v25, v25, v9
    v_mul_f32 v26, v26, v9
    v_mul_f32 v27, v27, v9
    v_mul_f32 v28, v28, v9
    v_mul_f32 v29, v29, v9
    v_mul_f32 v30, v30, v9
    v_mul_f32 v31, v31, v9
    v_cvt_pk_bf16_f32 v8, v16, v17
    v_cvt_pk_bf16_f32 v9, v18, v19
    v_cvt_pk_bf16_f32 v10, v20, v21
    v_cvt_pk_bf16_f32 v11, v22, v23
    v_cvt_pk_bf16_f32 v12, v24, v25
    v_cvt_pk_bf16_f32 v13, v26, v27
    v_cvt_pk_bf16_f32 v14, v28, v29
    v_cvt_pk_bf16_f32 v15, v30, v31
    ds_write_b128 v5, v[8:11] offset:4864
    ds_write_b128 v5, v[12:15] offset:5888
    s_waitcnt lgkmcnt(0)
    s_add_u32 s90, s90, 1
    s_and_b32 s6, s90, 0xfff
    s_barrier
    ds_read_b128 v[64:67], v3 offset:4864
    s_lshl_b32 s11, s10, 1
    v_add_u32 v5, s11, v2
    v_mul_u32_u24 v5, 1152, v5
    v_and_b32 v4, 7, v0
    v_mul_u32_u24 v4, 144, v4
    v_add_u32 v4, v4, v5
    s_lshl_b32 s11, s10, 2
    v_mov_b32 v5, s11
    s_waitcnt vmcnt(2)
    s_mov_b64 exec, 1
    ds_write_b32 v5, v7 offset:128
    s_mov_b64 exec, -1
    s_waitcnt vmcnt(0) lgkmcnt(0)
    v_perm_b32 v68, v36, v32, s7
    v_perm_b32 v69, v44, v40, s7
    v_perm_b32 v70, v52, v48, s7
    v_perm_b32 v71, v60, v56, s7
    v_perm_b32 v72, v36, v32, s8
    v_perm_b32 v73, v44, v40, s8
    v_perm_b32 v74, v52, v48, s8
    v_perm_b32 v75, v60, v56, s8
    v_mfma_f32_16x16x32_bf16 v[84:87], v[64:67], v[68:71], 0
    s_nop 0
    v_mfma_f32_16x16x32_bf16 v[88:91], v[64:67], v[72:75], 0
    v_perm_b32 v68, v37, v33, s7
    v_perm_b32 v69, v45, v41, s7
    v_perm_b32 v70, v53, v49, s7
    v_perm_b32 v71, v61, v57, s7
    v_perm_b32 v72, v37, v33, s8
    v_perm_b32 v73, v45, v41, s8
    v_perm_b32 v74, v53, v49, s8
    v_perm_b32 v75, v61, v57, s8
    v_mfma_f32_16x16x32_bf16 v[92:95], v[64:67], v[68:71], 0
    s_nop 0
    v_mfma_f32_16x16x32_bf16 v[96:99], v[64:67], v[72:75], 0
    v_perm_b32 v68, v38, v34, s7
    v_perm_b32 v69, v46, v42, s7
    v_perm_b32 v70, v54, v50, s7
    v_perm_b32 v71, v62, v58, s7
    v_perm_b32 v72, v38, v34, s8
    v_perm_b32 v73, v46, v42, s8
    v_perm_b32 v74, v54, v50, s8
    v_perm_b32 v75, v62, v58, s8
    v_mfma_f32_16x16x32_bf16 v[100:103], v[64:67], v[68:71], 0
    s_nop 0
    v_mfma_f32_16x16x32_bf16 v[104:107], v[64:67], v[72:75], 0
    v_perm_b32 v68, v39, v35, s7
    v_perm_b32 v69, v47, v43, s7
    v_perm_b32 v70, v55, v51, s7
    v_perm_b32 v71, v63, v59, s7
    v_perm_b32 v72, v39, v35, s8
    v_perm_b32 v73, v47, v43, s8
    v_perm_b32 v74, v55, v51, s8
    v_perm_b32 v75, v63, v59, s8
    v_mfma_f32_16x16x32_bf16 v[108:111], v[64:67], v[68:71], 0
    s_nop 0
    v_mfma_f32_16x16x32_bf16 v[112:115], v[64:67], v[72:75], 0
    s_mov_b64 exec, s[88:89]
    ds_write_b128 v4, v[84:87] offset:13056
    ds_write_b128 v4, v[88:91] offset:13072
    ds_write_b128 v4, v[92:95] offset:13088
    ds_write_b128 v4, v[96:99] offset:13104
    ds_write_b128 v4, v[100:103] offset:13120
    ds_write_b128 v4, v[104:107] offset:13136
    ds_write_b128 v4, v[108:111] offset:13152
    ds_write_b128 v4, v[112:115] offset:13168
    s_mov_b64 exec, -1
    s_mov_b64 exec, 1
    ds_add_rtn_u32 v5, v6, v7 offset:0
    s_waitcnt lgkmcnt(0)
    v_readfirstlane_b32 s11, v5
    s_mov_b64 exec, -1
    s_cmp_lg_u32 s11, 3
    s_cbranch_scc1 L_r0_qgather
    v_lshrrev_b32 v5, 3, v0
    v_mul_u32_u24 v5, 144, v5
    v_and_b32 v4, 7, v0
    v_lshl_add_u32 v4, v4, 4, v5
    ds_read_b128 v[32:35], v4 offset:13056
    ds_read_b128 v[36:39], v4 offset:14208
    ds_read_b128 v[40:43], v4 offset:15360
    ds_read_b128 v[44:47], v4 offset:16512
    ds_read_b128 v[48:51], v4 offset:17664
    ds_read_b128 v[52:55], v4 offset:18816
    ds_read_b128 v[56:59], v4 offset:19968
    ds_read_b128 v[60:63], v4 offset:21120
    s_waitcnt lgkmcnt(6)
    v_pk_add_f32 v[32:33], v[32:33], v[36:37]
    v_pk_add_f32 v[34:35], v[34:35], v[38:39]
    s_waitcnt lgkmcnt(4)
    v_pk_add_f32 v[40:41], v[40:41], v[44:45]
    v_pk_add_f32 v[42:43], v[42:43], v[46:47]
    s_waitcnt lgkmcnt(2)
    v_pk_add_f32 v[48:49], v[48:49], v[52:53]
    v_pk_add_f32 v[50:51], v[50:51], v[54:55]
    s_waitcnt lgkmcnt(0)
    v_pk_add_f32 v[56:57], v[56:57], v[60:61]
    v_pk_add_f32 v[58:59], v[58:59], v[62:63]
    v_pk_add_f32 v[32:33], v[32:33], v[40:41]
    v_pk_add_f32 v[34:35], v[34:35], v[42:43]
    v_pk_add_f32 v[48:49], v[48:49], v[56:57]
    v_pk_add_f32 v[50:51], v[50:51], v[58:59]
    v_and_b32 v4, 3, v0
    v_lshlrev_b32 v4, 17, v4
    v_lshrrev_b32 v5, 2, v0
    v_lshl_add_u32 v4, v5, 4, v4
    s_lshr_b32 s11, s63, 4
    s_lshl_b32 s11, s11, 15
    s_add_u32 s11, s11, 0x380000
    s_bitcmp1_b32 s69, 0
    s_cbranch_scc1 L_r0_split
    v_pk_add_f32 v[32:33], v[32:33], v[48:49]
    v_pk_add_f32 v[34:35], v[34:35], v[50:51]
    s_lshl_b32 s12, s68, 12
    s_add_u32 s11, s11, s12
    s_and_b32 s12, s63, 15
    s_lshl_b32 s12, s12, 8
    s_add_u32 s11, s11, s12
    v_mov_b32 v16, s6
    v_add_u32 v32, 0x800, v32
    v_add_u32 v33, 0x800, v33
    v_add_u32 v34, 0x800, v34
    v_add_u32 v35, 0x800, v35
    v_bfi_b32 v32, s91, v16, v32
    v_bfi_b32 v33, s91, v16, v33
    v_bfi_b32 v34, s91, v16, v34
    v_bfi_b32 v35, s91, v16, v35
    s_mov_b64 vcc, s[64:65]
    v_cndmask_b32_dpp v12, v33, v32, vcc quad_perm:[1,0,3,2] row_mask:0xf bank_mask:0xf
    v_cndmask_b32_dpp v14, v35, v34, vcc quad_perm:[1,0,3,2] row_mask:0xf bank_mask:0xf
    s_not_b64 vcc, vcc
    v_cndmask_b32_dpp v13, v32, v33, vcc quad_perm:[1,0,3,2] row_mask:0xf bank_mask:0xf
    v_cndmask_b32_dpp v15, v34, v35, vcc quad_perm:[1,0,3,2] row_mask:0xf bank_mask:0xf
    s_mov_b64 vcc, s[66:67]
    v_cndmask_b32_dpp v8, v14, v12, vcc quad_perm:[2,3,0,1] row_mask:0xf bank_mask:0xf
    v_cndmask_b32_dpp v9, v15, v13, vcc quad_perm:[2,3,0,1] row_mask:0xf bank_mask:0xf
    s_not_b64 vcc, vcc
    v_cndmask_b32_dpp v10, v12, v14, vcc quad_perm:[2,3,0,1] row_mask:0xf bank_mask:0xf
    v_cndmask_b32_dpp v11, v13, v15, vcc quad_perm:[2,3,0,1] row_mask:0xf bank_mask:0xf
    buffer_store_dwordx4 v[8:11], v4, s[48:51], s11 offen sc1
    s_branch L_r0_qgather
L_r0_split:
    s_and_b32 s12, s63, 8
    s_add_u32 s13, s12, 3
    s_lshl_b32 s13, s13, 8
    s_lshl_b32 s14, s68, 12
    s_add_u32 s13, s13, s14
    s_lshl_b32 s12, s12, 6
    s_lshl_b32 s14, s68, 10
    s_add_u32 s12, s12, s14
    s_add_u32 s12, s12, 16384
    s_bitcmp1_b32 s69, 1
    s_cselect_b32 s12, s12, s13
    s_cselect_b32 s13, 1, 4
    s_lshl_b32 s13, s13, 8
    s_add_u32 s11, s11, s12
    s_add_u32 s12, s11, s13
    v_mov_b32 v16, s6
    v_add_u32 v32, 0x800, v32
    v_add_u32 v33, 0x800, v33
    v_add_u32 v34, 0x800, v34
    v_add_u32 v35, 0x800, v35
    v_bfi_b32 v32, s91, v16, v32
    v_bfi_b32 v33, s91, v16, v33
    v_bfi_b32 v34, s91, v16, v34
    v_bfi_b32 v35, s91, v16, v35
    s_mov_b64 vcc, s[64:65]
    v_cndmask_b32_dpp v12, v33, v32, vcc quad_perm:[1,0,3,2] row_mask:0xf bank_mask:0xf
    v_cndmask_b32_dpp v14, v35, v34, vcc quad_perm:[1,0,3,2] row_mask:0xf bank_mask:0xf
    s_not_b64 vcc, vcc
    v_cndmask_b32_dpp v13, v32, v33, vcc quad_perm:[1,0,3,2] row_mask:0xf bank_mask:0xf
    v_cndmask_b32_dpp v15, v34, v35, vcc quad_perm:[1,0,3,2] row_mask:0xf bank_mask:0xf
    s_mov_b64 vcc, s[66:67]
    v_cndmask_b32_dpp v8, v14, v12, vcc quad_perm:[2,3,0,1] row_mask:0xf bank_mask:0xf
    v_cndmask_b32_dpp v9, v15, v13, vcc quad_perm:[2,3,0,1] row_mask:0xf bank_mask:0xf
    s_not_b64 vcc, vcc
    v_cndmask_b32_dpp v10, v12, v14, vcc quad_perm:[2,3,0,1] row_mask:0xf bank_mask:0xf
    v_cndmask_b32_dpp v11, v13, v15, vcc quad_perm:[2,3,0,1] row_mask:0xf bank_mask:0xf
    buffer_store_dwordx4 v[8:11], v4, s[48:51], s11 offen sc1
    v_mov_b32 v28, s6
    v_add_u32 v48, 0x800, v48
    v_add_u32 v49, 0x800, v49
    v_add_u32 v50, 0x800, v50
    v_add_u32 v51, 0x800, v51
    v_bfi_b32 v48, s91, v28, v48
    v_bfi_b32 v49, s91, v28, v49
    v_bfi_b32 v50, s91, v28, v50
    v_bfi_b32 v51, s91, v28, v51
    s_mov_b64 vcc, s[64:65]
    v_cndmask_b32_dpp v24, v49, v48, vcc quad_perm:[1,0,3,2] row_mask:0xf bank_mask:0xf
    v_cndmask_b32_dpp v26, v51, v50, vcc quad_perm:[1,0,3,2] row_mask:0xf bank_mask:0xf
    s_not_b64 vcc, vcc
    v_cndmask_b32_dpp v25, v48, v49, vcc quad_perm:[1,0,3,2] row_mask:0xf bank_mask:0xf
    v_cndmask_b32_dpp v27, v50, v51, vcc quad_perm:[1,0,3,2] row_mask:0xf bank_mask:0xf
    s_mov_b64 vcc, s[66:67]
    v_cndmask_b32_dpp v20, v26, v24, vcc quad_perm:[2,3,0,1] row_mask:0xf bank_mask:0xf
    v_cndmask_b32_dpp v21, v27, v25, vcc quad_perm:[2,3,0,1] row_mask:0xf bank_mask:0xf
    s_not_b64 vcc, vcc
    v_cndmask_b32_dpp v22, v24, v26, vcc quad_perm:[2,3,0,1] row_mask:0xf bank_mask:0xf
    v_cndmask_b32_dpp v23, v25, v27, vcc quad_perm:[2,3,0,1] row_mask:0xf bank_mask:0xf
    buffer_store_dwordx4 v[20:23], v4, s[48:51], s12 offen sc1
L_r0_qgather:
    s_lshl_b32 s11, s10, 2
    v_mov_b32 v64, s11
    v_lshlrev_b32 v4, 4, v0
    s_lshl_b32 s56, s61, 15
    s_add_u32 s56, s56, 0x380000
    s_lshl_b32 s11, s10, 8
    s_add_u32 s63, s56, s11
    s_add_u32 s63, s63, 16384
    s_lshl_b32 s11, s10, 10
    s_add_u32 s56, s56, s11
    s_add_u32 s57, s56, 4096
    s_add_u32 s58, s56, 8192
    s_add_u32 s59, s56, 12288
    v_lshlrev_b32 v65, 4, v1
    v_lshrrev_b32 v5, 5, v0
    s_lshl_b32 s11, s10, 1
    v_add_u32 v5, s11, v5
    v_mul_u32_u24 v5, 272, v5
    v_and_b32 v3, 31, v0
    v_lshl_add_u32 v5, v3, 3, v5
    s_mov_b32 s60, 2097152
L_wl_1:
    ds_read_b32 v3, v6 offset:80
    s_waitcnt lgkmcnt(0)
    v_readfirstlane_b32 s15, v3
    s_cmp_ge_u32 s15, 1
    s_cbranch_scc1 L_wld_2
    s_sleep 1
    s_sub_u32 s60, s60, 1
    s_cbranch_scc0 L_wl_1
L_wld_2:
    s_setprio 3
    s_mov_b32 s60, 2097152
L_poll_3:
    buffer_load_dwordx4 v[16:19], v4, s[48:51], s56 offen sc1
    buffer_load_dwordx4 v[20:23], v4, s[48:51], s57 offen sc1
    buffer_load_dwordx4 v[24:27], v4, s[48:51], s58 offen sc1
    buffer_load_dwordx4 v[28:31], v4, s[48:51], s59 offen sc1
    buffer_load_dwordx4 v[32:35], v65, s[48:51], s63 offen offset:0 sc1
    buffer_load_dwordx4 v[36:39], v65, s[48:51], s63 offen offset:1024 sc1
    buffer_load_dwordx4 v[40:43], v65, s[48:51], s63 offen offset:2048 sc1
    buffer_load_dwordx4 v[44:47], v65, s[48:51], s63 offen offset:3072 sc1
    s_waitcnt vmcnt(0)
    v_xor_b32 v16, s6, v16
    v_xor_b32 v17, s6, v17
    v_xor_b32 v18, s6, v18
    v_xor_b32 v19, s6, v19
    v_xor_b32 v20, s6, v20
    v_xor_b32 v21, s6, v21
    v_xor_b32 v22, s6, v22
    v_xor_b32 v23, s6, v23
    v_xor_b32 v24, s6, v24
    v_xor_b32 v25, s6, v25
    v_xor_b32 v26, s6, v26
    v_xor_b32 v27, s6, v27
    v_xor_b32 v28, s6, v28
    v_xor_b32 v29, s6, v29
    v_xor_b32 v30, s6, v30
    v_xor_b32 v31, s6, v31
    v_xor_b32 v32, s6, v32
    v_xor_b32 v33, s6, v33
    v_xor_b32 v34, s6, v34
    v_xor_b32 v35, s6, v35
    v_xor_b32 v36, s6, v36
    v_xor_b32 v37, s6, v37
    v_xor_b32 v38, s6, v38
    v_xor_b32 v39, s6, v39
    v_xor_b32 v40, s6, v40
    v_xor_b32 v41, s6, v41
    v_xor_b32 v42, s6, v42
    v_xor_b32 v43, s6, v43
    v_xor_b32 v44, s6, v44
    v_xor_b32 v45, s6, v45
    v_xor_b32 v46, s6, v46
    v_xor_b32 v47, s6, v47
    v_or_b32 v3, v16, v17
    v_or3_b32 v3, v3, v18, v19
    v_or3_b32 v3, v3, v20, v21
    v_or3_b32 v3, v3, v22, v23
    v_or3_b32 v3, v3, v24, v25
    v_or3_b32 v3, v3, v26, v27
    v_or3_b32 v3, v3, v28, v29
    v_or3_b32 v3, v3, v30, v31
    v_or3_b32 v3, v3, v32, v33
    v_or3_b32 v3, v3, v34, v35
    v_or3_b32 v3, v3, v36, v37
    v_or3_b32 v3, v3, v38, v39
    v_or3_b32 v3, v3, v40, v41
    v_or3_b32 v3, v3, v42, v43
    v_or3_b32 v3, v3, v44, v45
    v_or3_b32 v3, v3, v46, v47
    v_and_b32 v3, 0xfff, v3
    v_cmp_ne_u32 vcc, 0, v3
    s_and_b64 exec, exec, vcc
    s_cbranch_scc0 L_polld_4
    s_sleep 1
    s_sub_u32 s60, s60, 1
    s_cbranch_scc0 L_poll_3
L_polld_4:
    s_mov_b64 exec, -1
    v_pk_add_f32 v[16:17], v[16:17], v[20:21]
    v_pk_add_f32 v[24:25], v[24:25], v[28:29]
    v_pk_add_f32 v[18:19], v[18:19], v[22:23]
    v_pk_add_f32 v[26:27], v[26:27], v[30:31]
    v_pk_add_f32 v[32:33], v[32:33], v[36:37]
    v_pk_add_f32 v[40:41], v[40:41], v[44:45]
    v_pk_add_f32 v[34:35], v[34:35], v[38:39]
    v_pk_add_f32 v[42:43], v[42:43], v[46:47]
    v_pk_add_f32 v[16:17], v[16:17], v[24:25]
    v_pk_add_f32 v[18:19], v[18:19], v[26:27]
    v_pk_add_f32 v[32:33], v[32:33], v[40:41]
    v_pk_add_f32 v[34:35], v[34:35], v[42:43]
    s_mov_b32 exec_lo, 0
    s_mov_b32 exec_hi, 0xffff0000
    v_pk_add_f32 v[16:17], v[16:17], v[32:33]
    v_pk_add_f32 v[18:19], v[18:19], v[34:35]
    s_mov_b64 exec, -1
    v_cvt_pk_bf16_f32 v8, v16, v17
    v_cvt_pk_bf16_f32 v9, v18, v19
    ds_write_b64 v5, v[8:9] offset:512
    s_mov_b64 exec, 1
    ds_add_u32 v6, v7 offset:4
    s_mov_b64 exec, -1
    s_setprio 0
    s_mov_b32 s60, 2097152
L_wl_5:
    ds_read_b32 v3, v6 offset:24
    s_waitcnt lgkmcnt(0)
    v_readfirstlane_b32 s15, v3
    s_cmp_ge_u32 s15, 1
    s_cbranch_scc1 L_wld_6
    s_sleep 1
    s_sub_u32 s60, s60, 1
    s_cbranch_scc0 L_wl_5
L_wld_6:
    s_sub_u32 s11, s15, 1
    s_cmp_ge_u32 s11, 56
    s_cbranch_scc1 L_r0_noh
    s_lshl_b32 s11, s11, 8
    s_mul_i32 s56, s10, 14336
    s_add_u32 s56, s56, s11
    s_add_u32 s56, s56, 0x80000
    s_add_u32 s57, s56, 57344
    v_and_b32 v4, 1, v2
    v_mul_u32_u24 v4, 229376, v4
    v_lshrrev_b32 v5, 5, v0
    v_mul_u32_u24 v5, 114688, v5
    v_add_u32 v4, v4, v5
    v_lshl_add_u32 v4, v1, 4, v4
    s_mul_i32 s11, s10, 144
    v_lshlrev_b32 v5, 3, v1
    v_add_u32 v5, s11, v5
    s_mov_b32 s60, 2097152
L_wl_7:
    ds_read_b32 v3, v64 offset:96
    s_waitcnt lgkmcnt(0)
    v_readfirstlane_b32 s15, v3
    s_cmp_ge_u32 s15, 1
    s_cbranch_scc1 L_wld_8
    s_sleep 1
    s_sub_u32 s60, s60, 1
    s_cbranch_scc0 L_wl_7
L_wld_8:
    s_setprio 3
    s_mov_b32 s60, 2097152
L_poll_9:
    buffer_load_dwordx4 v[16:19], v4, s[48:51], s56 offen sc1
    buffer_load_dwordx4 v[20:23], v4, s[48:51], s57 offen sc1
    s_waitcnt vmcnt(0)
    v_xor_b32 v16, s6, v16
    v_xor_b32 v17, s6, v17
    v_xor_b32 v18, s6, v18
    v_xor_b32 v19, s6, v19
    v_xor_b32 v20, s6, v20
    v_xor_b32 v21, s6, v21
    v_xor_b32 v22, s6, v22
    v_xor_b32 v23, s6, v23
    v_or_b32 v3, v16, v17
    v_or3_b32 v3, v3, v18, v19
    v_or3_b32 v3, v3, v20, v21
    v_or3_b32 v3, v3, v22, v23
    v_and_b32 v3, 0xfff, v3
    v_cmp_ne_u32 vcc, 0, v3
    s_and_b64 exec, exec, vcc
    s_cbranch_scc0 L_polld_10
    s_sleep 1
    s_sub_u32 s60, s60, 1
    s_cbranch_scc0 L_poll_9
L_polld_10:
    s_mov_b64 exec, -1
    v_pk_add_f32 v[16:17], v[16:17], v[20:21]
    v_pk_add_f32 v[18:19], v[18:19], v[22:23]
    v_mov_b32 v20, v16
    v_mov_b32 v21, v17
    v_mov_b32 v22, v18
    v_mov_b32 v23, v19
    v_permlane32_swap_b32 v16, v20
    v_permlane32_swap_b32 v17, v21
    v_permlane32_swap_b32 v18, v22
    v_permlane32_swap_b32 v19, v23
    v_pk_add_f32 v[16:17], v[16:17], v[20:21]
    v_pk_add_f32 v[18:19], v[18:19], v[22:23]
    v_cvt_pk_bf16_f32 v16, v16, v17
    v_cvt_pk_bf16_f32 v17, v18, v19
    v_mov_b32 v18, v16
    v_mov_b32 v19, v17
    s_nop 0
    v_permlane16_swap_b32 v16, v18
    v_permlane16_swap_b32 v17, v19
    v_lshlrev_b32 v20, 16, v16
    v_and_b32 v21, 0xffff0000, v16
    v_lshlrev_b32 v22, 16, v17
    v_and_b32 v23, 0xffff0000, v17
    v_lshlrev_b32 v24, 16, v18
    v_and_b32 v25, 0xffff0000, v18
    v_lshlrev_b32 v26, 16, v19
    v_and_b32 v27, 0xffff0000, v19
    v_pk_mul_f32 v[20:21], v[20:21], v[24:25]
    v_pk_mul_f32 v[22:23], v[22:23], v[26:27]
    v_cvt_pk_bf16_f32 v8, v20, v21
    v_cvt_pk_bf16_f32 v9, v22, v23
    ds_write_b64 v5, v[8:9] offset:2688
    s_mov_b64 exec, 1
    ds_add_u32 v6, v7 offset:16
    s_mov_b64 exec, -1
L_r0_noh:
    s_endpgm
L_role1:
    v_lshlrev_b32 v4, 8, v1
    v_lshl_add_u32 v4, v2, 4, v4
    v_lshlrev_b32 v5, 10, v2
    v_lshl_add_u32 v5, v1, 4, v5
    s_lshl_b32 s56, s61, 21
    s_lshl2_add_u32 s11, s62, s10
    s_lshl_b32 s11, s11, 13
    s_add_u32 s56, s56, s11
    s_add_u32 s56, s56, 1572864
    s_add_u32 s57, s56, 4096
    s_waitcnt lgkmcnt(0)
    s_load_dword s90, s[38:39], 0
    s_mov_b32 s40, s18
    s_and_b32 s41, s19, 0xffff
    s_mov_b32 s42, 0x2000000
    s_mov_b32 s43, 0x20000
    s_mov_b32 s44, s20
    s_and_b32 s45, s21, 0xffff
    s_mov_b32 s46, 0x2000000
    s_mov_b32 s47, 0x20000
    s_mov_b32 s48, s38
    s_and_b32 s49, s39, 0xffff
    s_mov_b32 s50, 0x400000
    s_mov_b32 s51, 0x20000
    s_lshl_b32 s11, s10, 2
    v_mov_b32 v3, s11
    v_lshlrev_b32 v4, 4, v0
    s_waitcnt lgkmcnt(0)
    s_add_u32 s90, s90, 1
    s_and_b32 s6, s90, 0xfff
    s_barrier
    s_mov_b32 s60, 2097152
L_wl_11:
    ds_read_b32 v72, v3 offset:128
    s_waitcnt lgkmcnt(0)
    v_readfirstlane_b32 s15, v72
    s_cmp_ge_u32 s15, 1
    s_cbranch_scc1 L_wld_12
    s_sleep 1
    s_sub_u32 s60, s60, 1
    s_cbranch_scc0 L_wl_11
L_wld_12:
    buffer_load_dwordx4 v[8:11], v4, s[40:43], s56 offen offset:0 nt
    buffer_load_dwordx4 v[12:15], v4, s[40:43], s56 offen offset:1024 nt
    buffer_load_dwordx4 v[16:19], v4, s[40:43], s56 offen offset:2048 nt
    buffer_load_dwordx4 v[20:23], v4, s[40:43], s56 offen offset:3072 nt
    buffer_load_dwordx4 v[24:27], v4, s[40:43], s57 offen offset:0 nt
    buffer_load_dwordx4 v[28:31], v4, s[40:43], s57 offen offset:1024 nt
    buffer_load_dwordx4 v[32:35], v4, s[40:43], s57 offen offset:2048 nt
    buffer_load_dwordx4 v[36:39], v4, s[40:43], s57 offen offset:3072 nt
    s_waitcnt vmcnt(7)
    buffer_load_dwordx4 v[40:43], v5, s[44:47], s56 offen offset:0 nt
    s_waitcnt vmcnt(7)
    buffer_load_dwordx4 v[44:47], v5, s[44:47], s56 offen offset:256 nt
    s_waitcnt vmcnt(7)
    buffer_load_dwordx4 v[48:51], v5, s[44:47], s56 offen offset:512 nt
    s_waitcnt vmcnt(7)
    buffer_load_dwordx4 v[52:55], v5, s[44:47], s56 offen offset:768 nt
    s_waitcnt vmcnt(7)
    buffer_load_dwordx4 v[56:59], v5, s[44:47], s57 offen offset:0 nt
    s_waitcnt vmcnt(7)
    buffer_load_dwordx4 v[60:63], v5, s[44:47], s57 offen offset:256 nt
    s_waitcnt vmcnt(7)
    buffer_load_dwordx4 v[64:67], v5, s[44:47], s57 offen offset:512 nt
    s_waitcnt vmcnt(7)
    buffer_load_dwordx4 v[68:71], v5, s[44:47], s57 offen offset:768 nt
    s_waitcnt vmcnt(3)
    s_mov_b64 exec, 1
    ds_write_b32 v3, v7 offset:32
    s_mov_b64 exec, -1
    s_waitcnt vmcnt(2)
    s_mov_b64 exec, 1
    ds_write_b32 v6, v7 offset:80
    s_mov_b64 exec, -1
    v_and_b32 v104, 7, v0
    v_mul_u32_u24 v104, 272, v104
    v_lshl_add_u32 v104, v2, 4, v104
    s_lshl_b32 s13, s10, 6
    v_lshlrev_b32 v105, 2, v0
    v_add_u32 v105, s13, v105
    s_mul_i32 s13, s10, 4352
    v_mul_u32_u24 v4, 272, v1
    v_lshl_add_u32 v4, v2, 4, v4
    v_add_u32 v4, s13, v4
    v_bfe_u32 v5, v0, 3, 2
    s_lshl_b32 s11, s10, 2
    v_add_u32 v5, s11, v5
    v_mul_u32_u24 v5, 272, v5
    v_and_b32 v106, 7, v0
    v_lshl_add_u32 v5, v106, 5, v5
    v_lshrrev_b32 v106, 5, v0
    v_lshlrev_b32 v106, 4, v106
    v_add_u32 v5, v5, v106
    v_mov_b32 v109, s6
    v_lshrrev_b32 v110, 5, v0
    v_and_b32 v111, 3, v0
    v_lshl_add_u32 v110, v110, 2, v111
    v_lshlrev_b32 v111, 8, v110
    v_lshlrev_b32 v110, 13, v110
    v_bfe_u32 v108, v0, 2, 3
    v_lshl_add_u32 v110, v108, 4, v110
    s_lshl_b32 s58, s61, 16
    s_lshr_b32 s12, s10, 1
    s_lshl_b32 s12, s12, 12
    s_add_u32 s58, s58, s12
    s_lshl_b32 s12, s62, 8
    s_add_u32 s58, s58, s12
    s_and_b32 s12, s10, 1
    s_lshl_b32 s12, s12, 7
    s_add_u32 s58, s58, s12
    s_add_u32 s58, s58, 0x200000
    s_lshl_b32 s59, s61, 11
    s_lshl_b32 s12, s62, 4
    s_add_u32 s59, s59, s12
    s_add_u32 s59, s59, 0x50000
    v_lshlrev_b32 v112, 10, v2
    v_lshl_add_u32 v112, v1, 4, v112
    s_lshr_b32 s11, s4, 1
    s_lshl2_add_u32 s11, s10, s11
    s_and_b32 s12, s4, 1
    s_lshr_b32 s13, s5, 2
    s_lshl3_add_u32 s12, s12, s13
    s_lshl4_add_u32 s13, s11, s12
    s_lshl_b32 s56, s13, 12
    s_add_u32 s56, s56, 0x200000
    s_lshr_b32 s13, s13, 1
    s_lshl_b32 s57, s13, 8
    s_add_u32 s57, s57, 0x50000
    v_and_b32 v113, 3, v0
    v_lshl_add_u32 v113, v2, 2, v113
    v_lshlrev_b32 v113, 4, v113
    v_mov_b32 v115, v3
    s_mul_i32 s11, s10, 144
    v_lshlrev_b32 v114, 3, v1
    v_add_u32 v114, s11, v114
    s_mov_b32 s11, 0x3db504f3
    s_mov_b32 s12, 0x3fb8aa3b
    s_mul_i32 s13, s10, 8704
    s_add_u32 s13, s13, 67584
    v_mul_u32_u24 v116, 272, v2
    v_lshl_add_u32 v116, v1, 4, v116
    v_add_u32 v116, s13, v116
    v_mul_u32_u24 v117, 272, v1
    v_lshl_add_u32 v117, v2, 4, v117
    v_add_u32 v117, s13, v117
    s_waitcnt vmcnt(8)
    ds_write_b128 v116, v[8:11] offset:0
    ds_write_b128 v116, v[12:15] offset:1088
    ds_write_b128 v116, v[16:19] offset:2176
    ds_write_b128 v116, v[20:23] offset:3264
    ds_write_b128 v116, v[24:27] offset:4352
    ds_write_b128 v116, v[28:31] offset:5440
    ds_write_b128 v116, v[32:35] offset:6528
    ds_write_b128 v116, v[36:39] offset:7616
    s_waitcnt lgkmcnt(0)
    ds_read_b128 v[8:11], v117 offset:0
    ds_read_b128 v[12:15], v117 offset:64
    ds_read_b128 v[16:19], v117 offset:128
    ds_read_b128 v[20:23], v117 offset:192
    ds_read_b128 v[24:27], v117 offset:4352
    ds_read_b128 v[28:31], v117 offset:4416
    ds_read_b128 v[32:35], v117 offset:4480
    ds_read_b128 v[36:39], v117 offset:4544
    s_waitcnt vmcnt(0)
    v_perm_b32 v72, v44, v40, s7
    v_perm_b32 v73, v52, v48, s7
    v_perm_b32 v74, v60, v56, s7
    v_perm_b32 v75, v68, v64, s7
    v_perm_b32 v76, v44, v40, s8
    v_perm_b32 v77, v52, v48, s8
    v_perm_b32 v78, v60, v56, s8
    v_perm_b32 v79, v68, v64, s8
    v_perm_b32 v80, v45, v41, s7
    v_perm_b32 v81, v53, v49, s7
    v_perm_b32 v82, v61, v57, s7
    v_perm_b32 v83, v69, v65, s7
    v_perm_b32 v84, v45, v41, s8
    v_perm_b32 v85, v53, v49, s8
    v_perm_b32 v86, v61, v57, s8
    v_perm_b32 v87, v69, v65, s8
    v_perm_b32 v88, v46, v42, s7
    v_perm_b32 v89, v54, v50, s7
    v_perm_b32 v90, v62, v58, s7
    v_perm_b32 v91, v70, v66, s7
    v_perm_b32 v92, v46, v42, s8
    v_perm_b32 v93, v54, v50, s8
    v_perm_b32 v94, v62, v58, s8
    v_perm_b32 v95, v70, v66, s8
    v_perm_b32 v96, v47, v43, s7
    v_perm_b32 v97, v55, v51, s7
    v_perm_b32 v98, v63, v59, s7
    v_perm_b32 v99, v71, v67, s7
    v_perm_b32 v100, v47, v43, s8
    v_perm_b32 v101, v55, v51, s8
    v_perm_b32 v102, v63, v59, s8
    v_perm_b32 v103, v71, v67, s8
    s_mov_b32 s60, 2097152
L_wl_13:
    ds_read_b32 v3, v6 offset:4
    s_waitcnt lgkmcnt(0)
    v_readfirstlane_b32 s15, v3
    s_cmp_ge_u32 s15, 4
    s_cbranch_scc1 L_wld_14
    s_sub_u32 s60, s60, 1
    s_cbranch_scc0 L_wl_13
L_wld_14:
    s_setprio 3
    ds_read_b128 v[40:43], v104 offset:512
    ds_read_b128 v[44:47], v104 offset:576
    ds_read_b128 v[48:51], v104 offset:640
    ds_read_b128 v[52:55], v104 offset:704
    s_waitcnt lgkmcnt(3)
    v_mfma_f32_16x16x32_bf16 v[56:59], v[8:11], v[40:43], 0
    v_mfma_f32_16x16x32_bf16 v[60:63], v[24:27], v[40:43], 0
    s_waitcnt lgkmcnt(2)
    v_mfma_f32_16x16x32_bf16 v[56:59], v[12:15], v[44:47], v[56:59]
    v_mfma_f32_16x16x32_bf16 v[60:63], v[28:31], v[44:47], v[60:63]
    s_waitcnt lgkmcnt(1)
    v_mfma_f32_16x16x32_bf16 v[56:59], v[16:19], v[48:51], v[56:59]
    v_mfma_f32_16x16x32_bf16 v[60:63], v[32:35], v[48:51], v[60:63]
    s_waitcnt lgkmcnt(0)
    v_mfma_f32_16x16x32_bf16 v[56:59], v[20:23], v[52:55], v[56:59]
    v_mfma_f32_16x16x32_bf16 v[60:63], v[36:39], v[52:55], v[60:63]
    s_nop 6
    v_cvt_pk_bf16_f32 v57, v56, v57
    v_cvt_pk_bf16_f32 v59, v58, v59
    v_cvt_pk_bf16_f32 v61, v60, v61
    v_cvt_pk_bf16_f32 v63, v62, v63
    v_lshlrev_b32 v56, 16, v57
    v_and_b32 v57, 0xffff0000, v57
    v_lshlrev_b32 v58, 16, v59
    v_and_b32 v59, 0xffff0000, v59
    v_lshlrev_b32 v60, 16, v61
    v_and_b32 v61, 0xffff0000, v61
    v_lshlrev_b32 v62, 16, v63
    v_and_b32 v63, 0xffff0000, v63
    v_mul_f32 v56, s11, v56
    v_mul_f32 v57, s11, v57
    v_mul_f32 v58, s11, v58
    v_mul_f32 v59, s11, v59
    v_mul_f32 v60, s11, v60
    v_mul_f32 v61, s11, v61
    v_mul_f32 v62, s11, v62
    v_mul_f32 v63, s11, v63
    v_cvt_pk_bf16_f32 v57, v56, v57
    v_cvt_pk_bf16_f32 v59, v58, v59
    v_cvt_pk_bf16_f32 v61, v60, v61
    v_cvt_pk_bf16_f32 v63, v62, v63
    v_lshlrev_b32 v56, 16, v57
    v_and_b32 v57, 0xffff0000, v57
    v_lshlrev_b32 v58, 16, v59
    v_and_b32 v59, 0xffff0000, v59
    v_lshlrev_b32 v60, 16, v61
    v_and_b32 v61, 0xffff0000, v61
    v_lshlrev_b32 v62, 16, v63
    v_and_b32 v63, 0xffff0000, v63
    v_max3_f32 v68, v56, v57, v58
    v_max3_f32 v70, v59, v60, v61
    v_max3_f32 v68, v68, v62, v63
    v_max_f32 v68, v68, v70
    v_mov_b32 v70, v68
    s_nop 1
    v_permlane16_swap_b32 v68, v70
    v_max_f32 v68, v68, v70
    v_mov_b32 v70, v68
    s_nop 1
    v_permlane32_swap_b32 v68, v70
    v_max_f32 v68, v68, v70
    v_mul_f32 v68, s12, v68
    v_fma_f32 v56, v56, s12, -v68
    v_fma_f32 v57, v57, s12, -v68
    v_fma_f32 v58, v58, s12, -v68
    v_fma_f32 v59, v59, s12, -v68
    v_fma_f32 v60, v60, s12, -v68
    v_fma_f32 v61, v61, s12, -v68
    v_fma_f32 v62, v62, s12, -v68
    v_fma_f32 v63, v63, s12, -v68
    v_exp_f32 v56, v56
    v_exp_f32 v57, v57
    v_exp_f32 v58, v58
    v_exp_f32 v59, v59
    v_exp_f32 v60, v60
    v_exp_f32 v61, v61
    v_exp_f32 v62, v62
    v_exp_f32 v63, v63
    v_cvt_pk_bf16_f32 v64, v56, v57
    v_cvt_pk_bf16_f32 v65, v58, v59
    v_cvt_pk_bf16_f32 v66, v60, v61
    v_cvt_pk_bf16_f32 v67, v62, v63
    v_pk_add_f32 v[56:57], v[56:57], v[58:59]
    v_pk_add_f32 v[60:61], v[60:61], v[62:63]
    v_mfma_f32_16x16x32_bf16 v[8:11], v[64:67], v[72:75], 0
    v_pk_add_f32 v[56:57], v[56:57], v[60:61]
    v_mfma_f32_16x16x32_bf16 v[12:15], v[64:67], v[76:79], 0
    v_add_f32 v69, v56, v57
    v_mfma_f32_16x16x32_bf16 v[16:19], v[64:67], v[80:83], 0
    v_mov_b32 v70, v69
    s_nop 1
    v_permlane16_swap_b32 v69, v70
    v_add_f32 v69, v69, v70
    v_mov_b32 v70, v69
    s_nop 1
    v_permlane32_swap_b32 v69, v70
    v_add_f32 v69, v69, v70
    v_mfma_f32_16x16x32_bf16 v[20:23], v[64:67], v[84:87], 0
    v_mfma_f32_16x16x32_bf16 v[24:27], v[64:67], v[88:91], 0
    v_mfma_f32_16x16x32_bf16 v[28:31], v[64:67], v[92:95], 0
    v_mfma_f32_16x16x32_bf16 v[32:35], v[64:67], v[96:99], 0
    v_mfma_f32_16x16x32_bf16 v[36:39], v[64:67], v[100:103], 0
    s_mov_b64 exec, 0xff
    ds_write2_b32 v105, v68, v69 offset0:64 offset1:72
    s_mov_b64 exec, -1
    s_mov_b32 exec_hi, 0
    ds_write_b128 v4, v[8:11] offset:49920
    ds_write_b128 v4, v[12:15] offset:49952
    ds_write_b128 v4, v[16:19] offset:49984
    ds_write_b128 v4, v[20:23] offset:50016
    ds_write_b128 v4, v[24:27] offset:50048
    ds_write_b128 v4, v[28:31] offset:50080
    ds_write_b128 v4, v[32:35] offset:50112
    ds_write_b128 v4, v[36:39] offset:50144
    s_mov_b64 exec, -1
    s_mov_b64 exec, 1
    ds_add_u32 v6, v7 offset:8
    s_mov_b64 exec, -1
    s_mov_b32 s60, 2097152
L_wl_15:
    ds_read_b32 v4, v6 offset:8
    s_waitcnt lgkmcnt(0)
    v_readfirstlane_b32 s15, v4
    s_cmp_ge_u32 s15, 4
    s_cbranch_scc1 L_wld_16
    s_sub_u32 s60, s60, 1
    s_cbranch_scc0 L_wl_15
L_wld_16:
    ds_read_b128 v[8:11], v106 offset:256
    ds_read_b128 v[12:15], v106 offset:320
    ds_read_b128 v[16:19], v106 offset:384
    ds_read_b128 v[20:23], v106 offset:448
    ds_read_b128 v[24:27], v106 offset:288
    ds_read_b128 v[28:31], v106 offset:352
    ds_read_b128 v[32:35], v106 offset:416
    ds_read_b128 v[36:39], v106 offset:480
    ds_read_b128 v[40:43], v5 offset:49920
    ds_read_b128 v[44:47], v5 offset:54272
    ds_read_b128 v[48:51], v5 offset:58624
    ds_read_b128 v[52:55], v5 offset:62976
    s_waitcnt lgkmcnt(8)
    v_max3_f32 v56, v8, v12, v16
    v_max3_f32 v60, v9, v13, v17
    v_max3_f32 v64, v10, v14, v18
    v_max3_f32 v68, v11, v15, v19
    v_max_f32 v56, v56, v20
    v_max_f32 v60, v60, v21
    v_max_f32 v64, v64, v22
    v_max_f32 v68, v68, v23
    v_and_b32 v56, 0xfffff000, v56
    v_and_b32 v60, 0xfffff000, v60
    v_and_b32 v64, 0xfffff000, v64
    v_and_b32 v68, 0xfffff000, v68
    v_sub_f32 v8, v8, v56
    v_sub_f32 v9, v9, v60
    v_sub_f32 v10, v10, v64
    v_sub_f32 v11, v11, v68
    v_sub_f32 v12, v12, v56
    v_sub_f32 v13, v13, v60
    v_sub_f32 v14, v14, v64
    v_sub_f32 v15, v15, v68
    v_sub_f32 v16, v16, v56
    v_sub_f32 v17, v17, v60
    v_sub_f32 v18, v18, v64
    v_sub_f32 v19, v19, v68
    v_sub_f32 v20, v20, v56
    v_sub_f32 v21, v21, v60
    v_sub_f32 v22, v22, v64
    v_sub_f32 v23, v23, v68
    v_exp_f32 v8, v8
    v_exp_f32 v9, v9
    v_exp_f32 v10, v10
    v_exp_f32 v11, v11
    v_exp_f32 v12, v12
    v_exp_f32 v13, v13
    v_exp_f32 v14, v14
    v_exp_f32 v15, v15
    v_exp_f32 v16, v16
    v_exp_f32 v17, v17
    v_exp_f32 v18, v18
    v_exp_f32 v19, v19
    v_exp_f32 v20, v20
    v_exp_f32 v21, v21
    v_exp_f32 v22, v22
    v_exp_f32 v23, v23
    s_waitcnt lgkmcnt(0)
    v_mul_f32 v40, v8, v40
    v_mul_f32 v41, v9, v41
    v_mul_f32 v42, v10, v42
    v_mul_f32 v43, v11, v43
    v_fmac_f32 v40, v12, v44
    v_fmac_f32 v41, v13, v45
    v_fmac_f32 v42, v14, v46
    v_fmac_f32 v43, v15, v47
    v_fmac_f32 v40, v16, v48
    v_fmac_f32 v41, v17, v49
    v_fmac_f32 v42, v18, v50
    v_fmac_f32 v43, v19, v51
    v_fmac_f32 v40, v20, v52
    v_fmac_f32 v41, v21, v53
    v_fmac_f32 v42, v22, v54
    v_fmac_f32 v43, v23, v55
    v_mov_b32 v80, s6
    v_add_u32 v40, 0x800, v40
    v_add_u32 v41, 0x800, v41
    v_add_u32 v42, 0x800, v42
    v_add_u32 v43, 0x800, v43
    v_bfi_b32 v40, s91, v80, v40
    v_bfi_b32 v41, s91, v80, v41
    v_bfi_b32 v42, s91, v80, v42
    v_bfi_b32 v43, s91, v80, v43
    s_mov_b64 vcc, s[64:65]
    v_cndmask_b32_dpp v76, v41, v40, vcc quad_perm:[1,0,3,2] row_mask:0xf bank_mask:0xf
    v_cndmask_b32_dpp v78, v43, v42, vcc quad_perm:[1,0,3,2] row_mask:0xf bank_mask:0xf
    s_not_b64 vcc, vcc
    v_cndmask_b32_dpp v77, v40, v41, vcc quad_perm:[1,0,3,2] row_mask:0xf bank_mask:0xf
    v_cndmask_b32_dpp v79, v42, v43, vcc quad_perm:[1,0,3,2] row_mask:0xf bank_mask:0xf
    s_mov_b64 vcc, s[66:67]
    v_cndmask_b32_dpp v72, v78, v76, vcc quad_perm:[2,3,0,1] row_mask:0xf bank_mask:0xf
    v_cndmask_b32_dpp v73, v79, v77, vcc quad_perm:[2,3,0,1] row_mask:0xf bank_mask:0xf
    s_not_b64 vcc, vcc
    v_cndmask_b32_dpp v74, v76, v78, vcc quad_perm:[2,3,0,1] row_mask:0xf bank_mask:0xf
    v_cndmask_b32_dpp v75, v77, v79, vcc quad_perm:[2,3,0,1] row_mask:0xf bank_mask:0xf
    buffer_store_dwordx4 v[72:75], v110, s[48:51], s58 offen sc1
    s_cmp_lg_u32 s10, 0
    s_cbranch_scc1 L_r1_comb
    v_mul_f32 v57, v8, v24
    v_mul_f32 v61, v9, v25
    v_mul_f32 v65, v10, v26
    v_mul_f32 v69, v11, v27
    v_fmac_f32 v57, v12, v28
    v_fmac_f32 v61, v13, v29
    v_fmac_f32 v65, v14, v30
    v_fmac_f32 v69, v15, v31
    v_fmac_f32 v57, v16, v32
    v_fmac_f32 v61, v17, v33
    v_fmac_f32 v65, v18, v34
    v_fmac_f32 v69, v19, v35
    v_fmac_f32 v57, v20, v36
    v_fmac_f32 v61, v21, v37
    v_fmac_f32 v65, v22, v38
    v_fmac_f32 v69, v23, v39
    v_add_u32 v57, 0x800, v57
    v_add_u32 v61, 0x800, v61
    v_add_u32 v65, 0x800, v65
    v_add_u32 v69, 0x800, v69
    v_bfi_b32 v57, s91, v109, v57
    v_bfi_b32 v61, s91, v109, v61
    v_bfi_b32 v65, s91, v109, v65
    v_bfi_b32 v69, s91, v109, v69
    v_bfi_b32 v56, s91, v109, v56
    v_bfi_b32 v60, s91, v109, v60
    v_bfi_b32 v64, s91, v109, v64
    v_bfi_b32 v68, s91, v109, v68
    v_mov_b32 v58, v56
    v_mov_b32 v59, v57
    v_mov_b32 v62, v60
    v_mov_b32 v63, v61
    v_mov_b32 v66, v64
    v_mov_b32 v67, v65
    v_mov_b32 v70, v68
    v_mov_b32 v71, v69
    s_mov_b32 exec_lo, 1
    s_mov_b32 exec_hi, 1
    buffer_store_dwordx4 v[56:59], v111, s[48:51], s59 offen offset:0 sc1
    buffer_store_dwordx4 v[60:63], v111, s[48:51], s59 offen offset:256 sc1
    buffer_store_dwordx4 v[64:67], v111, s[48:51], s59 offen offset:512 sc1
    buffer_store_dwordx4 v[68:71], v111, s[48:51], s59 offen offset:768 sc1
    s_mov_b64 exec, -1
L_r1_comb:
    s_mov_b32 s60, 2097152
L_wl_17:
    ds_read_b32 v3, v115 offset:112
    s_waitcnt lgkmcnt(0)
    v_readfirstlane_b32 s15, v3
    s_cmp_ge_u32 s15, 1
    s_cbranch_scc1 L_wld_18
    s_sleep 1
    s_sub_u32 s60, s60, 1
    s_cbranch_scc0 L_wl_17
L_wld_18:
    s_setprio 3
    s_mov_b32 s60, 2097152
L_poll_19:
    buffer_load_dwordx4 v[32:35], v113, s[48:51], s57 offen sc1
    buffer_load_dwordx4 v[16:19], v112, s[48:51], s56 offen offset:0 sc1
    buffer_load_dwordx4 v[20:23], v112, s[48:51], s56 offen offset:256 sc1
    buffer_load_dwordx4 v[24:27], v112, s[48:51], s56 offen offset:512 sc1
    buffer_load_dwordx4 v[28:31], v112, s[48:51], s56 offen offset:768 sc1
    s_waitcnt vmcnt(0)
    v_xor_b32 v16, s6, v16
    v_xor_b32 v17, s6, v17
    v_xor_b32 v18, s6, v18
    v_xor_b32 v19, s6, v19
    v_xor_b32 v20, s6, v20
    v_xor_b32 v21, s6, v21
    v_xor_b32 v22, s6, v22
    v_xor_b32 v23, s6, v23
    v_xor_b32 v24, s6, v24
    v_xor_b32 v25, s6, v25
    v_xor_b32 v26, s6, v26
    v_xor_b32 v27, s6, v27
    v_xor_b32 v28, s6, v28
    v_xor_b32 v29, s6, v29
    v_xor_b32 v30, s6, v30
    v_xor_b32 v31, s6, v31
    v_xor_b32 v32, s6, v32
    v_xor_b32 v33, s6, v33
    v_xor_b32 v34, s6, v34
    v_xor_b32 v35, s6, v35
    v_or_b32 v3, v16, v17
    v_or3_b32 v3, v3, v18, v19
    v_or3_b32 v3, v3, v20, v21
    v_or3_b32 v3, v3, v22, v23
    v_or3_b32 v3, v3, v24, v25
    v_or3_b32 v3, v3, v26, v27
    v_or3_b32 v3, v3, v28, v29
    v_or3_b32 v3, v3, v30, v31
    v_or3_b32 v3, v3, v32, v33
    v_or3_b32 v3, v3, v34, v35
    v_and_b32 v3, 0xfff, v3
    v_cmp_ne_u32 vcc, 0, v3
    s_and_b64 exec, exec, vcc
    s_cbranch_scc0 L_polld_20
    s_sleep 1
    s_sub_u32 s60, s60, 1
    s_cbranch_scc0 L_poll_19
L_polld_20:
    s_mov_b64 exec, -1
    v_max_f32_dpp v36, v32, v32 quad_perm:[1,0,3,2] row_mask:0xf bank_mask:0xf
    s_nop 1
    v_max_f32_dpp v36, v36, v36 quad_perm:[2,3,0,1] row_mask:0xf bank_mask:0xf
    v_mov_b32 v37, v36
    s_nop 1
    v_permlane16_swap_b32 v36, v37
    v_max_f32 v36, v36, v37
    v_mov_b32 v37, v36
    s_nop 1
    v_permlane32_swap_b32 v36, v37
    v_max_f32 v36, v36, v37
    v_sub_f32 v32, v32, v36
    v_exp_f32 v32, v32
    s_nop 0
    v_mul_f32 v33, v32, v33
    v_mul_f32_dpp v40, v32, v16 quad_perm:[0,0,0,0] row_mask:0xf bank_mask:0xf
    v_mul_f32_dpp v41, v32, v17 quad_perm:[0,0,0,0] row_mask:0xf bank_mask:0xf
    v_mul_f32_dpp v42, v32, v18 quad_perm:[0,0,0,0] row_mask:0xf bank_mask:0xf
    v_mul_f32_dpp v43, v32, v19 quad_perm:[0,0,0,0] row_mask:0xf bank_mask:0xf
    v_fmac_f32_dpp v40, v32, v20 quad_perm:[1,1,1,1] row_mask:0xf bank_mask:0xf
    v_fmac_f32_dpp v41, v32, v21 quad_perm:[1,1,1,1] row_mask:0xf bank_mask:0xf
    v_fmac_f32_dpp v42, v32, v22 quad_perm:[1,1,1,1] row_mask:0xf bank_mask:0xf
    v_fmac_f32_dpp v43, v32, v23 quad_perm:[1,1,1,1] row_mask:0xf bank_mask:0xf
    v_fmac_f32_dpp v40, v32, v24 quad_perm:[2,2,2,2] row_mask:0xf bank_mask:0xf
    v_fmac_f32_dpp v41, v32, v25 quad_perm:[2,2,2,2] row_mask:0xf bank_mask:0xf
    v_fmac_f32_dpp v42, v32, v26 quad_perm:[2,2,2,2] row_mask:0xf bank_mask:0xf
    v_fmac_f32_dpp v43, v32, v27 quad_perm:[2,2,2,2] row_mask:0xf bank_mask:0xf
    v_fmac_f32_dpp v40, v32, v28 quad_perm:[3,3,3,3] row_mask:0xf bank_mask:0xf
    v_fmac_f32_dpp v41, v32, v29 quad_perm:[3,3,3,3] row_mask:0xf bank_mask:0xf
    v_fmac_f32_dpp v42, v32, v30 quad_perm:[3,3,3,3] row_mask:0xf bank_mask:0xf
    v_fmac_f32_dpp v43, v32, v31 quad_perm:[3,3,3,3] row_mask:0xf bank_mask:0xf
    v_add_f32_dpp v44, v33, v33 quad_perm:[1,0,3,2] row_mask:0xf bank_mask:0xf
    s_nop 1
    v_add_f32_dpp v44, v44, v44 quad_perm:[2,3,0,1] row_mask:0xf bank_mask:0xf
    v_mov_b32 v45, v40
    v_mov_b32 v46, v41
    v_mov_b32 v47, v42
    v_mov_b32 v48, v43
    v_mov_b32 v49, v44
    v_permlane16_swap_b32 v40, v45
    v_permlane16_swap_b32 v41, v46
    v_permlane16_swap_b32 v42, v47
    v_permlane16_swap_b32 v43, v48
    v_permlane16_swap_b32 v44, v49
    v_add_f32 v40, v40, v45
    v_add_f32 v41, v41, v46
    v_add_f32 v42, v42, v47
    v_add_f32 v43, v43, v48
    v_add_f32 v44, v44, v49
    v_mov_b32 v45, v40
    v_mov_b32 v46, v41
    v_mov_b32 v47, v42
    v_mov_b32 v48, v43
    v_mov_b32 v49, v44
    v_permlane32_swap_b32 v40, v45
    v_permlane32_swap_b32 v41, v46
    v_permlane32_swap_b32 v42, v47
    v_permlane32_swap_b32 v43, v48
    v_permlane32_swap_b32 v44, v49
    v_add_f32 v40, v40, v45
    v_add_f32 v41, v41, v46
    v_add_f32 v42, v42, v47
    v_add_f32 v43, v43, v48
    v_add_f32 v44, v44, v49
    v_rcp_f32 v44, v44
    s_nop 0
    v_mul_f32 v40, v40, v44
    v_mul_f32 v41, v41, v44
    v_mul_f32 v42, v42, v44
    v_mul_f32 v43, v43, v44
    v_cvt_pk_bf16_f32 v8, v40, v41
    v_cvt_pk_bf16_f32 v9, v42, v43
    ds_write_b64 v114, v[8:9] offset:40704
    s_mov_b64 exec, 1
    ds_add_u32 v6, v7 offset:20
    s_mov_b64 exec, -1
    s_endpgm
L_role2:
    v_lshrrev_b32 v3, 3, v1
    v_lshlrev_b32 v3, 2, v3
    v_add_u32 v3, v3, v2
    v_mul_u32_u24 v3, 57344, v3
    v_and_b32 v4, 7, v1
    v_lshl_add_u32 v4, v4, 4, v3
    s_lshr_b32 s11, s4, 1
    s_lshl2_add_u32 s11, s11, s10
    s_mul_i32 s56, s11, 458752
    s_and_b32 s12, s4, 1
    s_lshl1_add_u32 s12, s5, s12
    s_mul_i32 s13, s12, 37
    s_lshr_b32 s13, s13, 8
    s_mul_i32 s14, s13, 7
    s_sub_u32 s14, s12, s14
    s_cmp_ge_u32 s14, 3
    s_addc_u32 s14, s14, 0
    s_lshl3_add_u32 s63, s13, s14
    s_sub_u32 s13, s12, 49
    s_lshr_b32 s14, s13, 1
    s_lshl3_add_u32 s14, s14, 3
    s_and_b32 s13, s13, 1
    s_add_u32 s13, s13, 1
    s_cmp_ge_u32 s12, 49
    s_cselect_b32 s63, s14, s63
    s_cselect_b32 s69, s13, 0
    s_cmp_eq_u32 s12, 63
    s_cselect_b32 s69, 3, s69
    s_lshl_b32 s12, s63, 7
    s_add_u32 s56, s56, s12
    s_mov_b32 s57, s56
    v_and_b32 v3, 3, v1
    v_lshlrev_b32 v3, 11, v3
    v_bfe_u32 v5, v1, 2, 1
    v_lshl_add_u32 v3, v5, 6, v3
    v_lshl_add_u32 v3, v2, 4, v3
    s_lshl_b32 s11, s11, 7
    v_add_u32 v3, s11, v3
    s_waitcnt lgkmcnt(0)
    s_load_dword s90, s[38:39], 0
    s_cmp_eq_u32 s69, 2
    s_cselect_b32 s28, s30, s28
    s_cselect_b32 s29, s31, s29
    s_mov_b32 s40, s28
    s_and_b32 s41, s29, 0xffff
    s_mov_b32 s42, 0x700000
    s_mov_b32 s43, 0x20000
    s_mov_b32 s44, s30
    s_and_b32 s45, s31, 0xffff
    s_mov_b32 s46, 0x700000
    s_mov_b32 s47, 0x20000
    s_mov_b32 s48, s38
    s_and_b32 s49, s39, 0xffff
    s_mov_b32 s50, 0x400000
    s_mov_b32 s51, 0x20000
    s_mov_b32 s52, s36
    s_and_b32 s53, s37, 0xffff
    s_mov_b32 s54, 0x100
    s_mov_b32 s55, 0x20000
    s_waitcnt lgkmcnt(0)
    s_add_u32 s90, s90, 1
    s_and_b32 s6, s90, 0xfff
    s_barrier
    ds_read_b128 v[72:75], v3 offset:4864
    s_lshl_b32 s11, s10, 2
    v_mov_b32 v5, s11
    s_lshr_b32 s58, s4, 1
    s_mul_i32 s58, s58, 57344
    s_lshl_b32 s12, s63, 8
    s_add_u32 s58, s58, s12
    s_add_u32 s58, s58, 0x80000
    s_add_u32 s59, s58, 229376
    s_cmp_eq_u32 s69, 2
    s_cselect_b32 s58, s59, s58
    s_mov_b32 s60, 2097152
L_wl_21:
    ds_read_b32 v3, v5 offset:32
    s_waitcnt lgkmcnt(0)
    v_readfirstlane_b32 s15, v3
    s_cmp_ge_u32 s15, 1
    s_cbranch_scc1 L_wld_22
    s_sleep 1
    s_sub_u32 s60, s60, 1
    s_cbranch_scc0 L_wl_21
L_wld_22:
    s_cmp_eq_u32 s69, 3
    s_cbranch_scc0 L_r2_work
    s_mov_b64 exec, 1
    ds_write_b32 v5, v7 offset:48
    ds_write_b32 v5, v7 offset:144
    s_mov_b64 exec, -1
    s_waitcnt vmcnt(0)
    s_waitcnt vmcnt(0)
    s_branch L_r2_end
L_r2_work:
    buffer_load_dwordx4 v[8:11], v4, s[40:43], s56 offen nt
    s_add_u32 s56, s56, 7168
    buffer_load_dwordx4 v[12:15], v4, s[40:43], s56 offen nt
    s_add_u32 s56, s56, 7168
    buffer_load_dwordx4 v[16:19], v4, s[40:43], s56 offen nt
    s_add_u32 s56, s56, 7168
    buffer_load_dwordx4 v[20:23], v4, s[40:43], s56 offen nt
    s_add_u32 s56, s56, 7168
    buffer_load_dwordx4 v[24:27], v4, s[40:43], s56 offen nt
    s_add_u32 s56, s56, 7168
    buffer_load_dwordx4 v[28:31], v4, s[40:43], s56 offen nt
    s_add_u32 s56, s56, 7168
    buffer_load_dwordx4 v[32:35], v4, s[40:43], s56 offen nt
    s_add_u32 s56, s56, 7168
    buffer_load_dwordx4 v[36:39], v4, s[40:43], s56 offen nt
    s_cmp_lg_u32 s69, 0
    s_cbranch_scc1 L_r2_s1
    s_waitcnt vmcnt(7)
    buffer_load_dwordx4 v[40:43], v4, s[44:47], s57 offen nt
    s_add_u32 s57, s57, 7168
    s_waitcnt vmcnt(7)
    buffer_load_dwordx4 v[44:47], v4, s[44:47], s57 offen nt
    s_add_u32 s57, s57, 7168
    s_waitcnt vmcnt(7)
    buffer_load_dwordx4 v[48:51], v4, s[44:47], s57 offen nt
    s_add_u32 s57, s57, 7168
    s_waitcnt vmcnt(7)
    buffer_load_dwordx4 v[52:55], v4, s[44:47], s57 offen nt
    s_add_u32 s57, s57, 7168
    s_waitcnt vmcnt(7)
    buffer_load_dwordx4 v[56:59], v4, s[44:47], s57 offen nt
    s_add_u32 s57, s57, 7168
    s_waitcnt vmcnt(7)
    buffer_load_dwordx4 v[60:63], v4, s[44:47], s57 offen nt
    s_add_u32 s57, s57, 7168
    s_mov_b64 exec, 1
    ds_write_b32 v5, v7 offset:144
    s_mov_b64 exec, -1
    s_waitcnt vmcnt(7)
    buffer_load_dwordx4 v[64:67], v4, s[44:47], s57 offen nt
    s_add_u32 s57, s57, 7168
    s_waitcnt vmcnt(7)
    buffer_load_dwordx4 v[68:71], v4, s[44:47], s57 offen nt
    s_branch L_r2_s1b
L_r2_s1:
    s_mov_b64 exec, 1
    ds_write_b32 v5, v7 offset:144
    s_mov_b64 exec, -1
L_r2_s1b:
    s_lshl_b32 s11, s10, 1
    v_add_u32 v3, s11, v2
    v_mul_u32_u24 v3, 1152, v3
    v_and_b32 v4, 7, v0
    v_mul_u32_u24 v4, 144, v4
    v_add_u32 v4, v4, v3
    s_waitcnt vmcnt(3)
    s_mov_b64 exec, 1
    ds_write_b32 v5, v7 offset:48
    s_mov_b64 exec, -1
    s_cmp_eq_u32 s69, 0
    s_cbranch_scc1 L_r2_s2
    s_waitcnt vmcnt(0)
L_r2_s2:
    s_waitcnt vmcnt(8) lgkmcnt(0)
    v_and_b32 v124, 3, v0
    v_mul_u32_u24 v124, 14336, v124
    v_lshrrev_b32 v125, 2, v0
    v_lshl_add_u32 v124, v125, 4, v124
    v_perm_b32 v76, v12, v8, s7
    v_perm_b32 v77, v20, v16, s7
    v_perm_b32 v78, v28, v24, s7
    v_perm_b32 v79, v36, v32, s7
    v_perm_b32 v80, v12, v8, s8
    v_perm_b32 v81, v20, v16, s8
    v_perm_b32 v82, v28, v24, s8
    v_perm_b32 v83, v36, v32, s8
    v_mfma_f32_16x16x32_bf16 v[92:95], v[72:75], v[76:79], 0
    s_nop 0
    v_mfma_f32_16x16x32_bf16 v[96:99], v[72:75], v[80:83], 0
    v_perm_b32 v76, v13, v9, s7
    v_perm_b32 v77, v21, v17, s7
    v_perm_b32 v78, v29, v25, s7
    v_perm_b32 v79, v37, v33, s7
    v_perm_b32 v80, v13, v9, s8
    v_perm_b32 v81, v21, v17, s8
    v_perm_b32 v82, v29, v25, s8
    v_perm_b32 v83, v37, v33, s8
    v_mfma_f32_16x16x32_bf16 v[100:103], v[72:75], v[76:79], 0
    s_nop 0
    v_mfma_f32_16x16x32_bf16 v[104:107], v[72:75], v[80:83], 0
    v_perm_b32 v76, v14, v10, s7
    v_perm_b32 v77, v22, v18, s7
    v_perm_b32 v78, v30, v26, s7
    v_perm_b32 v79, v38, v34, s7
    v_perm_b32 v80, v14, v10, s8
    v_perm_b32 v81, v22, v18, s8
    v_perm_b32 v82, v30, v26, s8
    v_perm_b32 v83, v38, v34, s8
    v_mfma_f32_16x16x32_bf16 v[108:111], v[72:75], v[76:79], 0
    s_nop 0
    v_mfma_f32_16x16x32_bf16 v[112:115], v[72:75], v[80:83], 0
    v_perm_b32 v76, v15, v11, s7
    v_perm_b32 v77, v23, v19, s7
    v_perm_b32 v78, v31, v27, s7
    v_perm_b32 v79, v39, v35, s7
    v_perm_b32 v80, v15, v11, s8
    v_perm_b32 v81, v23, v19, s8
    v_perm_b32 v82, v31, v27, s8
    v_perm_b32 v83, v39, v35, s8
    v_mfma_f32_16x16x32_bf16 v[116:119], v[72:75], v[76:79], 0
    s_nop 0
    v_mfma_f32_16x16x32_bf16 v[120:123], v[72:75], v[80:83], 0
    s_mov_b64 exec, s[88:89]
    ds_write_b128 v4, v[92:95] offset:22272
    ds_write_b128 v4, v[96:99] offset:22288
    ds_write_b128 v4, v[100:103] offset:22304
    ds_write_b128 v4, v[104:107] offset:22320
    ds_write_b128 v4, v[108:111] offset:22336
    ds_write_b128 v4, v[112:115] offset:22352
    ds_write_b128 v4, v[116:119] offset:22368
    ds_write_b128 v4, v[120:123] offset:22384
    s_mov_b64 exec, -1
    s_cmp_lg_u32 s69, 0
    s_cbranch_scc1 L_r2_s3
    s_waitcnt vmcnt(0)
    v_perm_b32 v76, v44, v40, s7
    v_perm_b32 v77, v52, v48, s7
    v_perm_b32 v78, v60, v56, s7
    v_perm_b32 v79, v68, v64, s7
    v_perm_b32 v80, v44, v40, s8
    v_perm_b32 v81, v52, v48, s8
    v_perm_b32 v82, v60, v56, s8
    v_perm_b32 v83, v68, v64, s8
    v_mfma_f32_16x16x32_bf16 v[8:11], v[72:75], v[76:79], 0
    s_nop 0
    v_mfma_f32_16x16x32_bf16 v[12:15], v[72:75], v[80:83], 0
    v_perm_b32 v76, v45, v41, s7
    v_perm_b32 v77, v53, v49, s7
    v_perm_b32 v78, v61, v57, s7
    v_perm_b32 v79, v69, v65, s7
    v_perm_b32 v80, v45, v41, s8
    v_perm_b32 v81, v53, v49, s8
    v_perm_b32 v82, v61, v57, s8
    v_perm_b32 v83, v69, v65, s8
    v_mfma_f32_16x16x32_bf16 v[16:19], v[72:75], v[76:79], 0
    s_nop 0
    v_mfma_f32_16x16x32_bf16 v[20:23], v[72:75], v[80:83], 0
    v_perm_b32 v76, v46, v42, s7
    v_perm_b32 v77, v54, v50, s7
    v_perm_b32 v78, v62, v58, s7
    v_perm_b32 v79, v70, v66, s7
    v_perm_b32 v80, v46, v42, s8
    v_perm_b32 v81, v54, v50, s8
    v_perm_b32 v82, v62, v58, s8
    v_perm_b32 v83, v70, v66, s8
    v_mfma_f32_16x16x32_bf16 v[24:27], v[72:75], v[76:79], 0
    s_nop 0
    v_mfma_f32_16x16x32_bf16 v[28:31], v[72:75], v[80:83], 0
    v_perm_b32 v76, v47, v43, s7
    v_perm_b32 v77, v55, v51, s7
    v_perm_b32 v78, v63, v59, s7
    v_perm_b32 v79, v71, v67, s7
    v_perm_b32 v80, v47, v43, s8
    v_perm_b32 v81, v55, v51, s8
    v_perm_b32 v82, v63, v59, s8
    v_perm_b32 v83, v71, v67, s8
    v_mfma_f32_16x16x32_bf16 v[32:35], v[72:75], v[76:79], 0
    s_nop 0
    v_mfma_f32_16x16x32_bf16 v[36:39], v[72:75], v[80:83], 0
    s_mov_b64 exec, s[88:89]
    ds_write_b128 v4, v[8:11] offset:31488
    ds_write_b128 v4, v[12:15] offset:31504
    ds_write_b128 v4, v[16:19] offset:31520
    ds_write_b128 v4, v[20:23] offset:31536
    ds_write_b128 v4, v[24:27] offset:31552
    ds_write_b128 v4, v[28:31] offset:31568
    ds_write_b128 v4, v[32:35] offset:31584
    ds_write_b128 v4, v[36:39] offset:31600
    s_mov_b64 exec, -1
L_r2_s3:
    s_mov_b64 exec, 1
    ds_add_rtn_u32 v5, v6, v7 offset:12
    s_waitcnt lgkmcnt(0)
    v_readfirstlane_b32 s11, v5
    s_mov_b64 exec, -1
    s_cmp_lg_u32 s11, 3
    s_cbranch_scc1 L_r2_end
    v_lshrrev_b32 v5, 3, v0
    v_mul_u32_u24 v5, 144, v5
    v_and_b32 v4, 7, v0
    v_lshl_add_u32 v4, v4, 4, v5
    ds_read_b128 v[8:11], v4 offset:22272
    ds_read_b128 v[12:15], v4 offset:23424
    ds_read_b128 v[16:19], v4 offset:24576
    ds_read_b128 v[20:23], v4 offset:25728
    ds_read_b128 v[24:27], v4 offset:26880
    ds_read_b128 v[28:31], v4 offset:28032
    ds_read_b128 v[32:35], v4 offset:29184
    ds_read_b128 v[36:39], v4 offset:30336
    s_waitcnt lgkmcnt(6)
    v_pk_add_f32 v[8:9], v[8:9], v[12:13]
    v_pk_add_f32 v[10:11], v[10:11], v[14:15]
    s_waitcnt lgkmcnt(4)
    v_pk_add_f32 v[16:17], v[16:17], v[20:21]
    v_pk_add_f32 v[18:19], v[18:19], v[22:23]
    s_waitcnt lgkmcnt(2)
    v_pk_add_f32 v[24:25], v[24:25], v[28:29]
    v_pk_add_f32 v[26:27], v[26:27], v[30:31]
    s_waitcnt lgkmcnt(0)
    v_pk_add_f32 v[32:33], v[32:33], v[36:37]
    v_pk_add_f32 v[34:35], v[34:35], v[38:39]
    v_pk_add_f32 v[8:9], v[8:9], v[16:17]
    v_pk_add_f32 v[10:11], v[10:11], v[18:19]
    v_pk_add_f32 v[24:25], v[24:25], v[32:33]
    v_pk_add_f32 v[26:27], v[26:27], v[34:35]
    v_pk_add_f32 v[8:9], v[8:9], v[24:25]
    v_pk_add_f32 v[10:11], v[10:11], v[26:27]
    v_mov_b32 v80, s6
    v_add_u32 v8, 0x800, v8
    v_add_u32 v9, 0x800, v9
    v_add_u32 v10, 0x800, v10
    v_add_u32 v11, 0x800, v11
    v_bfi_b32 v8, s91, v80, v8
    v_bfi_b32 v9, s91, v80, v9
    v_bfi_b32 v10, s91, v80, v10
    v_bfi_b32 v11, s91, v80, v11
    s_mov_b64 vcc, s[64:65]
    v_cndmask_b32_dpp v76, v9, v8, vcc quad_perm:[1,0,3,2] row_mask:0xf bank_mask:0xf
    v_cndmask_b32_dpp v78, v11, v10, vcc quad_perm:[1,0,3,2] row_mask:0xf bank_mask:0xf
    s_not_b64 vcc, vcc
    v_cndmask_b32_dpp v77, v8, v9, vcc quad_perm:[1,0,3,2] row_mask:0xf bank_mask:0xf
    v_cndmask_b32_dpp v79, v10, v11, vcc quad_perm:[1,0,3,2] row_mask:0xf bank_mask:0xf
    s_mov_b64 vcc, s[66:67]
    v_cndmask_b32_dpp v72, v78, v76, vcc quad_perm:[2,3,0,1] row_mask:0xf bank_mask:0xf
    v_cndmask_b32_dpp v73, v79, v77, vcc quad_perm:[2,3,0,1] row_mask:0xf bank_mask:0xf
    s_not_b64 vcc, vcc
    v_cndmask_b32_dpp v74, v76, v78, vcc quad_perm:[2,3,0,1] row_mask:0xf bank_mask:0xf
    v_cndmask_b32_dpp v75, v77, v79, vcc quad_perm:[2,3,0,1] row_mask:0xf bank_mask:0xf
    buffer_store_dwordx4 v[72:75], v124, s[48:51], s58 offen sc1
    s_cmp_lg_u32 s69, 0
    s_cbranch_scc1 L_r2_s4
    ds_read_b128 v[40:43], v4 offset:31488
    ds_read_b128 v[44:47], v4 offset:32640
    ds_read_b128 v[48:51], v4 offset:33792
    ds_read_b128 v[52:55], v4 offset:34944
    ds_read_b128 v[56:59], v4 offset:36096
    ds_read_b128 v[60:63], v4 offset:37248
    ds_read_b128 v[64:67], v4 offset:38400
    ds_read_b128 v[68:71], v4 offset:39552
    s_waitcnt lgkmcnt(6)
    v_pk_add_f32 v[40:41], v[40:41], v[44:45]
    v_pk_add_f32 v[42:43], v[42:43], v[46:47]
    s_waitcnt lgkmcnt(4)
    v_pk_add_f32 v[48:49], v[48:49], v[52:53]
    v_pk_add_f32 v[50:51], v[50:51], v[54:55]
    s_waitcnt lgkmcnt(2)
    v_pk_add_f32 v[56:57], v[56:57], v[60:61]
    v_pk_add_f32 v[58:59], v[58:59], v[62:63]
    s_waitcnt lgkmcnt(0)
    v_pk_add_f32 v[64:65], v[64:65], v[68:69]
    v_pk_add_f32 v[66:67], v[66:67], v[70:71]
    v_pk_add_f32 v[40:41], v[40:41], v[48:49]
    v_pk_add_f32 v[42:43], v[42:43], v[50:51]
    v_pk_add_f32 v[56:57], v[56:57], v[64:65]
    v_pk_add_f32 v[58:59], v[58:59], v[66:67]
    v_pk_add_f32 v[40:41], v[40:41], v[56:57]
    v_pk_add_f32 v[42:43], v[42:43], v[58:59]
    v_mov_b32 v92, s6
    v_add_u32 v40, 0x800, v40
    v_add_u32 v41, 0x800, v41
    v_add_u32 v42, 0x800, v42
    v_add_u32 v43, 0x800, v43
    v_bfi_b32 v40, s91, v92, v40
    v_bfi_b32 v41, s91, v92, v41
    v_bfi_b32 v42, s91, v92, v42
    v_bfi_b32 v43, s91, v92, v43
    s_mov_b64 vcc, s[64:65]
    v_cndmask_b32_dpp v88, v41, v40, vcc quad_perm:[1,0,3,2] row_mask:0xf bank_mask:0xf
    v_cndmask_b32_dpp v90, v43, v42, vcc quad_perm:[1,0,3,2] row_mask:0xf bank_mask:0xf
    s_not_b64 vcc, vcc
    v_cndmask_b32_dpp v89, v40, v41, vcc quad_perm:[1,0,3,2] row_mask:0xf bank_mask:0xf
    v_cndmask_b32_dpp v91, v42, v43, vcc quad_perm:[1,0,3,2] row_mask:0xf bank_mask:0xf
    s_mov_b64 vcc, s[66:67]
    v_cndmask_b32_dpp v84, v90, v88, vcc quad_perm:[2,3,0,1] row_mask:0xf bank_mask:0xf
    v_cndmask_b32_dpp v85, v91, v89, vcc quad_perm:[2,3,0,1] row_mask:0xf bank_mask:0xf
    s_not_b64 vcc, vcc
    v_cndmask_b32_dpp v86, v88, v90, vcc quad_perm:[2,3,0,1] row_mask:0xf bank_mask:0xf
    v_cndmask_b32_dpp v87, v89, v91, vcc quad_perm:[2,3,0,1] row_mask:0xf bank_mask:0xf
    buffer_store_dwordx4 v[84:87], v124, s[48:51], s59 offen sc1
L_r2_s4:
L_r2_end:
    s_endpgm
L_role3:
    v_lshlrev_b32 v4, 14, v2
    v_lshl_add_u32 v4, v1, 3, v4
    s_lshr_b32 s11, s5, 2
    s_lshl3_add_u32 s63, s4, s11
    s_sub_u32 s68, s63, s4
    s_sub_u32 s68, s68, 1
    s_and_b32 s12, s5, 3
    s_lshl2_add_u32 s12, s12, s10
    s_lshl_b32 s13, s12, 7
    s_lshl_b32 s56, s63, 17
    s_add_u32 s56, s56, s13
    s_lshl_b32 s57, s68, 17
    s_add_u32 s57, s57, s13
    s_mov_b32 s69, s13
    s_cmp_lt_u32 s5, 4
    s_cselect_b32 s68, 99, s68
    s_lshl_b32 s58, s12, 16
    s_lshl_b32 s13, s63, 6
    s_add_u32 s58, s58, s13
    s_add_u32 s58, s58, 0x100000
    v_lshrrev_b32 v5, 2, v1
    v_add_u32 v3, v1, v5
    v_and_b32 v3, 3, v3
    v_mul_u32_u24 v3, 144, v3
    v_lshl_add_u32 v3, v2, 4, v3
    v_mov_b32 v104, 0
    v_mov_b32 v105, 0
    v_mov_b32 v106, 0
    v_mov_b32 v107, 0
    v_mov_b32 v108, 0
    v_mov_b32 v109, 0
    v_mov_b32 v110, 0
    v_mov_b32 v111, 0
    v_mov_b32 v112, 0
    v_mov_b32 v113, 0
    v_mov_b32 v114, 0
    v_mov_b32 v115, 0
    v_mov_b32 v116, 0
    v_mov_b32 v117, 0
    v_mov_b32 v118, 0
    v_mov_b32 v119, 0
    s_waitcnt lgkmcnt(0)
    s_load_dword s90, s[38:39], 0
    s_mov_b32 s40, s24
    s_and_b32 s41, s25, 0xffff
    s_mov_b32 s42, 0x800000
    s_mov_b32 s43, 0x20000
    s_mov_b32 s44, s32
    s_and_b32 s45, s33, 0xffff
    s_mov_b32 s46, 0x700000
    s_mov_b32 s47, 0x20000
    s_mov_b32 s48, s38
    s_and_b32 s49, s39, 0xffff
    s_mov_b32 s50, 0x400000
    s_mov_b32 s51, 0x20000
    s_mov_b32 s52, s16
    s_and_b32 s53, s17, 0xffff
    s_mov_b32 s54, 0x2000
    s_mov_b32 s55, 0x20000
    s_bfe_u32 s11, s2, 0x20002
    s_lshl_b32 s11, s11, 11
    s_lshr_b32 s12, s2, 4
    s_lshl_b32 s12, s12, 7
    s_add_u32 s11, s11, s12
    s_and_b32 s12, s2, 3
    s_lshl_b32 s12, s12, 5
    s_add_u32 s59, s11, s12
    s_waitcnt lgkmcnt(0)
    s_add_u32 s90, s90, 1
    s_and_b32 s6, s90, 0xfff
    s_barrier
    s_lshl_b32 s11, s10, 2
    v_mov_b32 v5, s11
    s_cmp_lg_u32 s10, 0
    s_cbranch_scc1 L_r3_noclaim
    s_mov_b32 s92, s36
    s_and_b32 s93, s37, 0xffff
    s_mov_b32 s94, 256
    s_mov_b32 s95, 0x20000
    s_mov_b32 s60, 2097152
L_wl_23:
    ds_read_b32 v120, v5 offset:144
    s_waitcnt lgkmcnt(0)
    v_readfirstlane_b32 s15, v120
    s_cmp_ge_u32 s15, 1
    s_cbranch_scc1 L_wld_24
    s_sleep 1
    s_sub_u32 s60, s60, 1
    s_cbranch_scc0 L_wl_23
L_wld_24:
    s_and_b32 s11, s5, 3
    s_lshl_b32 s11, s11, 6
    v_mov_b32 v120, 1
    s_mov_b64 exec, 1
    buffer_atomic_add v120, v6, s[92:95], s11 offen sc0
    s_waitcnt vmcnt(0)
    v_and_b32 v120, 63, v120
    v_add_u32 v120, 1, v120
    ds_write_b32 v6, v120 offset:24
    s_mov_b64 exec, -1
L_r3_noclaim:
    s_mov_b32 s60, 2097152
L_wl_25:
    ds_read_b32 v120, v5 offset:48
    s_waitcnt lgkmcnt(0)
    v_readfirstlane_b32 s15, v120
    s_cmp_ge_u32 s15, 1
    s_cbranch_scc1 L_wld_26
    s_sleep 1
    s_sub_u32 s60, s60, 1
    s_cbranch_scc0 L_wl_25
L_wld_26:
    buffer_load_dwordx2 v[8:9], v4, s[40:43], s56 offen offset:0 nt
    buffer_load_dwordx2 v[10:11], v4, s[40:43], s56 offen offset:2048 nt
    s_add_u32 s56, s56, 4096
    buffer_load_dwordx2 v[12:13], v4, s[40:43], s56 offen offset:0 nt
    buffer_load_dwordx2 v[14:15], v4, s[40:43], s56 offen offset:2048 nt
    s_add_u32 s56, s56, 4096
    buffer_load_dwordx2 v[16:17], v4, s[40:43], s56 offen offset:0 nt
    buffer_load_dwordx2 v[18:19], v4, s[40:43], s56 offen offset:2048 nt
    s_add_u32 s56, s56, 4096
    buffer_load_dwordx2 v[20:21], v4, s[40:43], s56 offen offset:0 nt
    buffer_load_dwordx2 v[22:23], v4, s[40:43], s56 offen offset:2048 nt
    s_add_u32 s56, s56, 53248
    buffer_load_dwordx2 v[24:25], v4, s[40:43], s56 offen offset:0 nt
    buffer_load_dwordx2 v[26:27], v4, s[40:43], s56 offen offset:2048 nt
    s_add_u32 s56, s56, 4096
    buffer_load_dwordx2 v[28:29], v4, s[40:43], s56 offen offset:0 nt
    buffer_load_dwordx2 v[30:31], v4, s[40:43], s56 offen offset:2048 nt
    s_add_u32 s56, s56, 4096
    buffer_load_dwordx2 v[32:33], v4, s[40:43], s56 offen offset:0 nt
    buffer_load_dwordx2 v[34:35], v4, s[40:43], s56 offen offset:2048 nt
    s_add_u32 s56, s56, 4096
    buffer_load_dwordx2 v[36:37], v4, s[40:43], s56 offen offset:0 nt
    buffer_load_dwordx2 v[38:39], v4, s[40:43], s56 offen offset:2048 nt
    s_mov_b32 s60, 2097152
L_wl_29:
    ds_read_b32 v120, v6 offset:24
    s_waitcnt lgkmcnt(0)
    v_readfirstlane_b32 s15, v120
    s_cmp_ge_u32 s15, 1
    s_cbranch_scc1 L_wld_30
    s_sleep 1
    s_sub_u32 s60, s60, 1
    s_cbranch_scc0 L_wl_29
L_wld_30:
    s_sub_u32 s68, s15, 1
    s_lshl_b32 s57, s68, 17
    s_add_u32 s57, s57, s69
    s_cmp_ge_u32 s68, 56
    s_cbranch_scc1 L_nod_27
    s_waitcnt vmcnt(14)
    buffer_load_dwordx2 v[40:41], v4, s[44:47], s57 offen offset:0 nt
    buffer_load_dwordx2 v[42:43], v4, s[44:47], s57 offen offset:2048 nt
    s_add_u32 s57, s57, 4096
    s_waitcnt vmcnt(14)
    buffer_load_dwordx2 v[44:45], v4, s[44:47], s57 offen offset:0 nt
    buffer_load_dwordx2 v[46:47], v4, s[44:47], s57 offen offset:2048 nt
    s_add_u32 s57, s57, 4096
    s_waitcnt vmcnt(14)
    buffer_load_dwordx2 v[48:49], v4, s[44:47], s57 offen offset:0 nt
    buffer_load_dwordx2 v[50:51], v4, s[44:47], s57 offen offset:2048 nt
    s_add_u32 s57, s57, 4096
    s_waitcnt vmcnt(14)
    buffer_load_dwordx2 v[52:53], v4, s[44:47], s57 offen offset:0 nt
    buffer_load_dwordx2 v[54:55], v4, s[44:47], s57 offen offset:2048 nt
    s_add_u32 s57, s57, 53248
    s_waitcnt vmcnt(14)
    buffer_load_dwordx2 v[56:57], v4, s[44:47], s57 offen offset:0 nt
    buffer_load_dwordx2 v[58:59], v4, s[44:47], s57 offen offset:2048 nt
    s_add_u32 s57, s57, 4096
    s_waitcnt vmcnt(14)
    buffer_load_dwordx2 v[60:61], v4, s[44:47], s57 offen offset:0 nt
    buffer_load_dwordx2 v[62:63], v4, s[44:47], s57 offen offset:2048 nt
    s_add_u32 s57, s57, 4096
    s_waitcnt vmcnt(14)
    buffer_load_dwordx2 v[64:65], v4, s[44:47], s57 offen offset:0 nt
    buffer_load_dwordx2 v[66:67], v4, s[44:47], s57 offen offset:2048 nt
    s_add_u32 s57, s57, 4096
    s_waitcnt vmcnt(14)
    buffer_load_dwordx2 v[68:69], v4, s[44:47], s57 offen offset:0 nt
    buffer_load_dwordx2 v[70:71], v4, s[44:47], s57 offen offset:2048 nt
    s_branch L_nodx_28
L_nod_27:
    s_mov_b64 exec, 1
    ds_write_b32 v5, v7 offset:96
    ds_write_b32 v5, v7 offset:112
    s_mov_b64 exec, -1
    s_waitcnt vmcnt(0)
L_nodx_28:
    s_waitcnt vmcnt(8)
    s_mov_b64 exec, 1
    ds_write_b32 v5, v7 offset:112
    s_mov_b64 exec, -1
    s_waitcnt vmcnt(4)
    s_mov_b64 exec, 1
    ds_write_b32 v5, v7 offset:96
    s_mov_b64 exec, -1
    s_waitcnt vmcnt(16)
    v_perm_b32 v72, v10, v8, s7
    v_perm_b32 v73, v14, v12, s7
    v_perm_b32 v74, v18, v16, s7
    v_perm_b32 v75, v22, v20, s7
    v_perm_b32 v76, v10, v8, s8
    v_perm_b32 v77, v14, v12, s8
    v_perm_b32 v78, v18, v16, s8
    v_perm_b32 v79, v22, v20, s8
    v_perm_b32 v80, v11, v9, s7
    v_perm_b32 v81, v15, v13, s7
    v_perm_b32 v82, v19, v17, s7
    v_perm_b32 v83, v23, v21, s7
    v_perm_b32 v84, v11, v9, s8
    v_perm_b32 v85, v15, v13, s8
    v_perm_b32 v86, v19, v17, s8
    v_perm_b32 v87, v23, v21, s8
    v_perm_b32 v88, v26, v24, s7
    v_perm_b32 v89, v30, v28, s7
    v_perm_b32 v90, v34, v32, s7
    v_perm_b32 v91, v38, v36, s7
    v_perm_b32 v92, v26, v24, s8
    v_perm_b32 v93, v30, v28, s8
    v_perm_b32 v94, v34, v32, s8
    v_perm_b32 v95, v38, v36, s8
    v_perm_b32 v96, v27, v25, s7
    v_perm_b32 v97, v31, v29, s7
    v_perm_b32 v98, v35, v33, s7
    v_perm_b32 v99, v39, v37, s7
    v_perm_b32 v100, v27, v25, s8
    v_perm_b32 v101, v31, v29, s8
    v_perm_b32 v102, v35, v33, s8
    v_perm_b32 v103, v39, v37, s8
    s_waitcnt vmcnt(0)
    v_perm_b32 v8, v42, v40, s7
    v_perm_b32 v9, v46, v44, s7
    v_perm_b32 v10, v50, v48, s7
    v_perm_b32 v11, v54, v52, s7
    v_perm_b32 v12, v42, v40, s8
    v_perm_b32 v13, v46, v44, s8
    v_perm_b32 v14, v50, v48, s8
    v_perm_b32 v15, v54, v52, s8
    v_perm_b32 v16, v43, v41, s7
    v_perm_b32 v17, v47, v45, s7
    v_perm_b32 v18, v51, v49, s7
    v_perm_b32 v19, v55, v53, s7
    v_perm_b32 v20, v43, v41, s8
    v_perm_b32 v21, v47, v45, s8
    v_perm_b32 v22, v51, v49, s8
    v_perm_b32 v23, v55, v53, s8
    v_perm_b32 v24, v58, v56, s7
    v_perm_b32 v25, v62, v60, s7
    v_perm_b32 v26, v66, v64, s7
    v_perm_b32 v27, v70, v68, s7
    v_perm_b32 v28, v58, v56, s8
    v_perm_b32 v29, v62, v60, s8
    v_perm_b32 v30, v66, v64, s8
    v_perm_b32 v31, v70, v68, s8
    v_perm_b32 v32, v59, v57, s7
    v_perm_b32 v33, v63, v61, s7
    v_perm_b32 v34, v67, v65, s7
    v_perm_b32 v35, v71, v69, s7
    v_perm_b32 v36, v59, v57, s8
    v_perm_b32 v37, v63, v61, s8
    v_perm_b32 v38, v67, v65, s8
    v_perm_b32 v39, v71, v69, s8
    v_lshrrev_b32 v41, 2, v1
    v_lshlrev_b32 v40, 14, v2
    v_lshl_add_u32 v40, v41, 12, v40
    v_and_b32 v41, 3, v1
    v_lshl_add_u32 v40, v41, 4, v40
    v_lshlrev_b32 v41, 3, v41
    v_lshlrev_b32 v43, 4, v0
    s_lshl_b32 s56, s2, 12
    s_add_u32 s56, s56, 0x100000
    v_mov_b32 v42, s6
    buffer_load_dwordx2 v[44:45], v41, s[52:55], s59 offen
    s_mov_b32 s52, s34
    s_and_b32 s53, s35, 0xffff
    s_mov_b32 s54, 0x2000
    s_mov_b32 s55, 0x20000
    s_mov_b32 s60, 2097152
L_wl_32:
    ds_read_b32 v120, v6 offset:20
    s_waitcnt lgkmcnt(0)
    v_readfirstlane_b32 s15, v120
    s_cmp_ge_u32 s15, 4
    s_cbranch_scc1 L_wld_33
    s_sub_u32 s60, s60, 1
    s_cbranch_scc0 L_wl_32
L_wld_33:
    ds_read_b128 v[120:123], v3 offset:40704
    ds_read_b128 v[124:127], v3 offset:40768
    s_waitcnt lgkmcnt(1)
    v_mfma_f32_16x16x32_bf16 v[104:107], v[120:123], v[72:75], v[104:107]
    v_mfma_f32_16x16x32_bf16 v[108:111], v[120:123], v[76:79], v[108:111]
    v_mfma_f32_16x16x32_bf16 v[112:115], v[120:123], v[80:83], v[112:115]
    v_mfma_f32_16x16x32_bf16 v[116:119], v[120:123], v[84:87], v[116:119]
    s_waitcnt lgkmcnt(0)
    v_mfma_f32_16x16x32_bf16 v[104:107], v[124:127], v[88:91], v[104:107]
    v_mfma_f32_16x16x32_bf16 v[108:111], v[124:127], v[92:95], v[108:111]
    v_mfma_f32_16x16x32_bf16 v[112:115], v[124:127], v[96:99], v[112:115]
    v_mfma_f32_16x16x32_bf16 v[116:119], v[124:127], v[100:103], v[116:119]
L_nom_31:
    s_cmp_ge_u32 s68, 56
    s_cbranch_scc1 L_nom_34
    s_mov_b32 s60, 2097152
L_wl_35:
    ds_read_b32 v120, v6 offset:16
    s_waitcnt lgkmcnt(0)
    v_readfirstlane_b32 s15, v120
    s_cmp_ge_u32 s15, 4
    s_cbranch_scc1 L_wld_36
    s_sub_u32 s60, s60, 1
    s_cbranch_scc0 L_wl_35
L_wld_36:
    ds_read_b128 v[120:123], v3 offset:2688
    ds_read_b128 v[124:127], v3 offset:2752
    s_waitcnt lgkmcnt(1)
    v_mfma_f32_16x16x32_bf16 v[104:107], v[120:123], v[8:11], v[104:107]
    v_mfma_f32_16x16x32_bf16 v[108:111], v[120:123], v[12:15], v[108:111]
    v_mfma_f32_16x16x32_bf16 v[112:115], v[120:123], v[16:19], v[112:115]
    v_mfma_f32_16x16x32_bf16 v[116:119], v[120:123], v[20:23], v[116:119]
    s_waitcnt lgkmcnt(0)
    v_mfma_f32_16x16x32_bf16 v[104:107], v[124:127], v[24:27], v[104:107]
    v_mfma_f32_16x16x32_bf16 v[108:111], v[124:127], v[28:31], v[108:111]
    v_mfma_f32_16x16x32_bf16 v[112:115], v[124:127], v[32:35], v[112:115]
    v_mfma_f32_16x16x32_bf16 v[116:119], v[124:127], v[36:39], v[116:119]
L_nom_34:
    s_nop 7
    v_add_u32 v48, 0x800, v104
    v_add_u32 v49, 0x800, v108
    v_add_u32 v50, 0x800, v112
    v_add_u32 v51, 0x800, v116
    v_bfi_b32 v48, s91, v42, v48
    v_bfi_b32 v49, s91, v42, v49
    v_bfi_b32 v50, s91, v42, v50
    v_bfi_b32 v51, s91, v42, v51
    buffer_store_dwordx4 v[48:51], v40, s[48:51], s58 offen sc1
    s_cmp_lg_u32 s10, 0
    s_cbranch_scc1 L_r3_end
    s_waitcnt vmcnt(0)
    s_setprio 3
    s_mov_b32 s60, 2097152
L_poll_37:
    buffer_load_dwordx4 v[8:11], v43, s[48:51], s56 offen offset:0 sc1
    buffer_load_dwordx4 v[12:15], v43, s[48:51], s56 offen offset:1024 sc1
    buffer_load_dwordx4 v[16:19], v43, s[48:51], s56 offen offset:2048 sc1
    buffer_load_dwordx4 v[20:23], v43, s[48:51], s56 offen offset:3072 sc1
    s_waitcnt vmcnt(0)
    v_xor_b32 v8, s6, v8
    v_xor_b32 v9, s6, v9
    v_xor_b32 v10, s6, v10
    v_xor_b32 v11, s6, v11
    v_xor_b32 v12, s6, v12
    v_xor_b32 v13, s6, v13
    v_xor_b32 v14, s6, v14
    v_xor_b32 v15, s6, v15
    v_xor_b32 v16, s6, v16
    v_xor_b32 v17, s6, v17
    v_xor_b32 v18, s6, v18
    v_xor_b32 v19, s6, v19
    v_xor_b32 v20, s6, v20
    v_xor_b32 v21, s6, v21
    v_xor_b32 v22, s6, v22
    v_xor_b32 v23, s6, v23
    v_or_b32 v5, v8, v9
    v_or3_b32 v5, v5, v10, v11
    v_or3_b32 v5, v5, v12, v13
    v_or3_b32 v5, v5, v14, v15
    v_or3_b32 v5, v5, v16, v17
    v_or3_b32 v5, v5, v18, v19
    v_or3_b32 v5, v5, v20, v21
    v_or3_b32 v5, v5, v22, v23
    v_and_b32 v5, 0xfff, v5
    v_cmp_ne_u32 vcc, 0, v5
    s_and_b64 exec, exec, vcc
    s_cbranch_scc0 L_polld_38
    s_sleep 2
    s_sub_u32 s60, s60, 1
    s_cbranch_scc0 L_poll_37
L_polld_38:
    s_mov_b64 exec, -1
    v_pk_add_f32 v[8:9], v[8:9], v[12:13]
    v_pk_add_f32 v[10:11], v[10:11], v[14:15]
    v_pk_add_f32 v[16:17], v[16:17], v[20:21]
    v_pk_add_f32 v[18:19], v[18:19], v[22:23]
    v_pk_add_f32 v[56:57], v[8:9], v[16:17]
    v_pk_add_f32 v[58:59], v[10:11], v[18:19]
    v_lshlrev_b32 v64, 16, v44
    v_and_b32 v65, 0xffff0000, v44
    v_add_f32_dpp v56, v56, v56 row_ror:4 row_mask:0xf bank_mask:0xf
    v_add_f32_dpp v57, v57, v57 row_ror:4 row_mask:0xf bank_mask:0xf
    v_add_f32_dpp v58, v58, v58 row_ror:4 row_mask:0xf bank_mask:0xf
    v_add_f32_dpp v59, v59, v59 row_ror:4 row_mask:0xf bank_mask:0xf
    v_add_f32_dpp v56, v56, v56 row_ror:8 row_mask:0xf bank_mask:0xf
    v_add_f32_dpp v57, v57, v57 row_ror:8 row_mask:0xf bank_mask:0xf
    v_add_f32_dpp v58, v58, v58 row_ror:8 row_mask:0xf bank_mask:0xf
    v_add_f32_dpp v59, v59, v59 row_ror:8 row_mask:0xf bank_mask:0xf
    v_lshlrev_b32 v66, 16, v45
    v_and_b32 v67, 0xffff0000, v45
    v_mov_b32 v60, v56
    v_mov_b32 v61, v57
    v_mov_b32 v62, v58
    v_mov_b32 v63, v59
    v_permlane16_swap_b32 v56, v60
    v_permlane16_swap_b32 v57, v61
    v_permlane16_swap_b32 v58, v62
    v_permlane16_swap_b32 v59, v63
    v_add_f32 v56, v56, v60
    v_add_f32 v57, v57, v61
    v_add_f32 v58, v58, v62
    v_add_f32 v59, v59, v63
    v_mov_b32 v60, v56
    v_mov_b32 v61, v57
    v_mov_b32 v62, v58
    v_mov_b32 v63, v59
    v_permlane32_swap_b32 v56, v60
    v_permlane32_swap_b32 v57, v61
    v_permlane32_swap_b32 v58, v62
    v_permlane32_swap_b32 v59, v63
    v_add_f32 v56, v56, v60
    v_add_f32 v57, v57, v61
    v_add_f32 v58, v58, v62
    v_add_f32 v59, v59, v63
    v_pk_add_f32 v[56:57], v[56:57], v[64:65]
    v_pk_add_f32 v[58:59], v[58:59], v[66:67]
    v_cvt_pk_bf16_f32 v64, v56, v57
    v_cvt_pk_bf16_f32 v65, v58, v59
    s_mov_b64 exec, 15
    buffer_store_dwordx2 v[64:65], v41, s[52:55], s59 offen
    s_cmp_lg_u32 s2, 0
    s_cbranch_scc1 L_r3_noep
    s_mov_b64 exec, 1
    v_mov_b32 v66, s90
    buffer_store_dword v66, v6, s[48:51], 0 offen sc1
L_r3_noep:
    s_mov_b64 exec, -1
L_r3_end:
    s_endpgm
L_exit:
    s_endpgm
L_code_end:
.section .rodata,"a"
.p2align 6
.amdhsa_kernel parallel_sum__sliding_block_cached__glu_gated_bilinear__decode_kernel
  .amdhsa_next_free_vgpr 128
  .amdhsa_next_free_sgpr 96
  .amdhsa_accum_offset 128
  .amdhsa_group_segment_fixed_size 0
  .amdhsa_kernarg_size 96
  .amdhsa_user_sgpr_count 2
  .amdhsa_user_sgpr_kernarg_segment_ptr 1
  .amdhsa_system_sgpr_workgroup_id_x 1
  .amdhsa_float_denorm_mode_32 3
.end_amdhsa_kernel
```
